```python
import torch

def _softmax(x, axis=-1):
    return torch.softmax(x, dim=axis)
def _gelu(x):
    return torch.nn.functional.gelu(x, approximate="tanh")
def _silu(x):
    return torch.nn.functional.silu(x)
def _sigmoid(x):
    return torch.sigmoid(x)
def _layernorm(x, axis=-1, eps=1e-5):
    m = x.mean(dim=axis, keepdim=True)
    v = x.var(dim=axis, keepdim=True, unbiased=False)
    return (x - m) / torch.sqrt(v + eps)
def _scatter_add(tgt, idx, src, axis=0):
    return tgt.clone().index_add_(axis, idx, src)
def _segment_sum(src, seg, n):
    out = torch.zeros((n,) + src.shape[1:], dtype=src.dtype)
    return out.index_add_(0, seg, src)
def _pad(x, pw):
    flat = tuple(v for pair in reversed(pw) for v in pair)
    return torch.nn.functional.pad(x, flat)

kernel_name = 'gated_mix__linear_kernel_hedgehog__sliding_block__prompt'

def setup_inputs():

    _w = (lambda a: (lambda t: t.to(torch.bfloat16) if t.is_floating_point() else t)(torch.as_tensor(a)))
    def _A_setup():
        B, S, D, H = 1, 2048, 448, 16
        Dh = D // H
        return {
            "x": _w((lambda *s: torch.randn(*s, dtype=torch.bfloat16) * 0.05)(B, S, D)),
            "wqkv": _w((lambda *s: torch.randn(*s, dtype=torch.bfloat16) * 3.2)(D, 3 * D)),
            "w_phi": _w((lambda *s: torch.randn(*s, dtype=torch.bfloat16) * 3.2)(H, Dh, Dh) * (Dh ** -0.5)),
            "wo": _w((lambda *s: torch.randn(*s, dtype=torch.bfloat16) * 0.1)(D, D)),
        }
    _A_in = _A_setup()

    def _B_setup():
        B, S, D = 1, 2048, 448
        return {
            "x": _w((lambda *s: torch.randn(*s, dtype=torch.bfloat16) * 0.05)(B, S, D)),
            "wqkv": _w((lambda *s: torch.randn(*s, dtype=torch.bfloat16) * 1.6)(D, 3 * D)),
            "wo": _w((lambda *s: torch.randn(*s, dtype=torch.bfloat16) * 0.05)(D, D)),
        }
    _B_in = _B_setup()

    return {
        "A_x": _A_in["x"],
        "A_wqkv": _A_in["wqkv"],
        "A_w_phi": _A_in["w_phi"],
        "A_wo": _A_in["wo"],
        "B_x": _B_in["x"],
        "B_wqkv": _B_in["wqkv"],
        "B_wo": _B_in["wo"],
        "gate_w": _w((lambda *s: torch.randn(*s, dtype=torch.bfloat16) * 0.05)(448) * 16.0),
    }

def reference(A_x, A_wqkv, A_w_phi, A_wo, B_x, B_wqkv, B_wo, gate_w):
    def _A_ref(x, wqkv, w_phi, wo):
        B, S, D = x.shape
        H = 16; Dh = D // H
        qkv = (lambda x, *d: x.permute(*d))((x @ wqkv).reshape(B, S, 3, H, Dh), 2, 0, 3, 1, 4)
        q, k, v = qkv[0], qkv[1], qkv[2]
        pq = torch.einsum("bhsd,hdf->bhsf", q, w_phi)
        pk = torch.einsum("bhsd,hdf->bhsf", k, w_phi)
        phi_q = torch.concatenate([_softmax(pq, axis=-1), _softmax(-pq, axis=-1)], axis=-1)
        phi_k = torch.concatenate([_softmax(pk, axis=-1), _softmax(-pk, axis=-1)], axis=-1)
        kv = torch.einsum("bhsf,bhsd->bhfd", phi_k, v)
        z  = torch.einsum("bhsf->bhf", phi_k)
        num = torch.einsum("bhqf,bhfd->bhqd", phi_q, kv)
        den = torch.einsum("bhqf,bhf->bhq", phi_q, z)[..., None] + 1e-6
        o = num / den
        return (lambda x, *d: x.permute(*d))(o, 0, 2, 1, 3).reshape(B, S, D) @ wo

    def _B_ref(x, wqkv, wo):
        B, S, D = x.shape
        H = 16; Dh = D // H; W = 256
        qkv = (lambda x, *d: x.permute(*d))((x @ wqkv).reshape(B, S, 3, H, Dh), 2, 0, 3, 1, 4)
        q, k, v = qkv[0], qkv[1], qkv[2]
        scores = torch.einsum("bhqd,bhkd->bhqk", q, k) * (Dh ** -0.5)
        idx = torch.arange(S)
        mask = (idx[:, None] - idx[None, :] >= 0) & (idx[:, None] - idx[None, :] < W)
        scores = torch.where(mask[None, None], scores, -1e9)
        p = _softmax(scores, axis=-1)
        o = torch.einsum("bhqk,bhkd->bhqd", p, v)
        return (lambda x, *d: x.permute(*d))(o, 0, 2, 1, 3).reshape(B, S, D) @ wo

    x = A_x
    g = _sigmoid((x * gate_w).sum(-1, keepdims=True))
    a = _A_ref(x, A_wqkv, A_w_phi, A_wo)
    b = _B_ref(x, B_wqkv, B_wo)
    return g * a + (1 - g) * b
```

```asm
; @launch grid=(256,1,1) block=(512,1,1) lds=163840
.amdgcn_target "amdgcn-amd-amdhsa--gfx950"
.text
.globl gated_mix__linear_kernel_hedgehog__sliding_block__prompt_kernel
.p2align 8
.type gated_mix__linear_kernel_hedgehog__sliding_block__prompt_kernel,@function
gated_mix__linear_kernel_hedgehog__sliding_block__prompt_kernel:
    s_lshr_b32 s63, s2, 7
    s_cmp_ge_u32 s63, 2
    s_cbranch_scc1 L_end
    s_load_dwordx2 s[28:29], s[0:1], 0
    s_lshl_b32 s87, s63, 5
    s_load_dwordx2 s[56:57], s[0:1], 56
    s_add_u32 s87, s87, 8
    s_load_dwordx2 s[36:37], s[0:1], 80
    s_load_dwordx2 s[32:33], s[0:1], s87
    s_getpc_b64 s[94:95]
    v_lshrrev_b32 v12, 6, v0
    s_lshr_b32 s61, s2, 3
    v_readfirstlane_b32 s66, v12
    v_and_b32 v13, 63, v0
    s_and_b32 s94, s94, 0xffffff00
    s_lshl3_add_u32 s87, s61, s66
    s_lshl_b32 s87, s87, 7
    v_and_b32 v14, 32, v0
    v_lshl_add_u32 v14, v14, 10, s87
    v_min_u32 v14, 0x8d34, v14
    global_load_dword v22, v14, s[94:95]
    s_and_b32 s64, s61, 7
    s_and_b32 s87, s2, 1
    s_lshl3_add_u32 s65, s87, s64
    s_lshr_b32 s89, s61, 3
    s_mul_i32 s70, s89, 7
    s_lshr_b32 s70, s70, 2
    s_add_u32 s70, s70, s64
    s_sub_u32 s87, s70, 7
    s_min_u32 s70, s70, s87
    v_lshrrev_b32 v14, 3, v13
    v_and_b32 v15, 7, v13
    v_lshrrev_b32 v16, 4, v13
    v_xor_b32 v17, v15, v16
    s_lshl3_add_u32 s87, s65, s66
    s_mul_i32 s87, s87, 14336
    v_mul_u32_u24 v18, 896, v14
    v_add_u32 v18, s87, v18
    v_lshl_add_u32 v32, v17, 4, v18
    v_xor_b32 v33, 64, v32
    v_add_u32 v33, 6144, v33
    v_min_u32 v26, 447, v0
    v_lshlrev_b32 v27, 1, v26
    s_lshl_b32 s71, s66, 11
    s_lshl_b32 s73, s70, 7
    s_mov_b32 s30, 1835008
    s_mov_b32 s31, 0x20000
    s_add_u32 m0, s71, 131072
    s_waitcnt lgkmcnt(0)
    global_load_ushort v28, v27, s[56:57]
    buffer_load_dwordx4 v32, s[28:31], s73 offen offset:0 lds
    buffer_load_dwordx4 v33, s[28:31], s73 offen offset:1024 lds
    s_load_dword s26, s[36:37], 0
    s_load_dwordx2 s[40:41], s[0:1], 24
    s_load_dwordx2 s[44:45], s[0:1], 48
    s_load_dwordx2 s[48:49], s[0:1], 64
    s_load_dwordx2 s[52:53], s[0:1], 16
    s_and_b32 s89, s89, 1
    s_and_b32 s62, s2, 6
    s_add_u32 s62, s62, s89
    v_and_b32 v17, 1, v16
    v_lshlrev_b32 v17, 2, v17
    v_xor_b32 v17, v17, v15
    v_and_b32 v12, 1, v12
    v_lshlrev_b32 v12, 1, v12
    v_xor_b32 v17, v17, v12
    v_mul_u32_u24 v18, 2688, v14
    v_lshl_add_u32 v18, v17, 4, v18
    s_mul_i32 s87, s66, 21504
    s_lshl4_add_u32 s88, s63, 112
    s_mul_i32 s88, s88, s62
    s_add_u32 s88, s88, s87
    s_cmp_eq_u32 s62, 7
    s_cselect_b32 s89, 0, 8
    s_cmp_eq_u32 s63, 1
    s_cselect_b32 s89, s89, 7
    v_add_u32 v19, s88, v18
    v_cmp_le_u32 vcc, s89, v17
    v_mov_b32 v20, 0x7f000000
    s_mul_i32 s88, s62, 112
    s_add_u32 s88, s88, s87
    v_cndmask_b32 v34, v19, v20, vcc
    v_add_u32 v35, s88, v18
    s_lshl_b32 s72, s66, 10
    s_mul_i32 s80, s70, 172032
    s_mov_b32 s34, 1204224
    s_mov_b32 s35, 0x20000
    s_add_u32 m0, s72, 146560
    s_nop 0
    buffer_load_dwordx4 v34, s[32:35], s80 offen offset:896 lds
    s_cmp_eq_u32 s63, 1
    s_cbranch_scc1 L_pathB
    s_add_u32 s87, s70, 1
    s_sub_u32 s88, s87, 7
    s_min_u32 s87, s87, s88
    s_lshl_b32 s74, s87, 7
    s_mul_i32 s81, s87, 172032
    s_add_u32 m0, s71, 81920
    s_nop 0
    buffer_load_dwordx4 v32, s[28:31], s74 offen offset:0 lds
    buffer_load_dwordx4 v33, s[28:31], s74 offen offset:1024 lds
    s_bfe_u32 s60, s2, 0x20001
    s_and_b32 s64, s2, 1
    s_xor_b32 s64, s64, 1
    s_lshl2_add_u32 s60, s64, s60
    s_mov_b32 s38, 0xb00000
    s_mov_b32 s39, 0x20000
    s_mov_b32 s43, 0x20000
    s_mov_b32 s47, 0x20000
    s_mov_b32 s50, 1835008
    s_mov_b32 s51, 0x20000
    s_mov_b32 s54, 25088
    s_mov_b32 s55, 0x20000
    s_cmp_ge_u32 s61, 4
    s_cselect_b32 s42, 401408, 0
    s_cselect_b32 s46, 401408, 0
    s_cselect_b32 s21, 1, 0
    s_mov_b32 s59, 0
    s_mov_b32 s90, 0
    s_mov_b32 s91, -1
    s_mov_b32 s8, 0xf7f77f7f
    s_bitcmp1_b32 s66, 0
    s_cselect_b32 s8, 0xfdfddfdf, s8
    s_mov_b32 s9, s8
    s_mov_b32 s10, -1
    s_mov_b32 s11, 0xffff
    s_mov_b32 s12, 0x77ff77ff
    s_mov_b32 s13, 0x77ff77ff
    s_lshr_b32 s96, s66, 2
    s_bfe_u32 s67, s66, 0x10001
    s_and_b32 s68, s66, 1
    s_lshl1_add_u32 s69, s62, s68
    s_lshl1_add_u32 s3, s67, s96
    s_lshl2_add_u32 s14, s65, s3
    v_lshlrev_b32 v1, 4, v13
    s_add_u32 s87, s70, 2
    s_sub_u32 s88, s87, 7
    s_min_u32 s87, s87, s88
    s_lshl_b32 s75, s87, 7
    s_mul_i32 s82, s87, 172032
    s_add_u32 s87, s70, 3
    s_sub_u32 s88, s87, 7
    s_min_u32 s87, s87, s88
    s_lshl_b32 s76, s87, 7
    s_mul_i32 s83, s87, 172032
    s_add_u32 s87, s70, 4
    s_sub_u32 s88, s87, 7
    s_min_u32 s87, s87, s88
    s_lshl_b32 s77, s87, 7
    s_mul_i32 s84, s87, 172032
    s_add_u32 s87, s70, 5
    s_sub_u32 s88, s87, 7
    s_min_u32 s87, s87, s88
    s_lshl_b32 s78, s87, 7
    s_mul_i32 s85, s87, 172032
    s_add_u32 s87, s70, 6
    s_sub_u32 s88, s87, 7
    s_min_u32 s87, s87, s88
    s_lshl_b32 s79, s87, 7
    s_mul_i32 s86, s87, 172032
    s_lshl_b32 s87, s70, 6
    v_subrev_u32 v18, s87, v26
    v_add_u32 v19, 448, v18
    v_min_u32 v18, v18, v19
    v_bfe_u32 v19, v18, 1, 1
    v_lshlrev_b32 v19, 6, v19
    v_xor_b32 v19, 112, v19
    v_and_b32 v20, 8, v18
    v_lshlrev_b32 v20, 2, v20
    v_xor_b32 v19, v19, v20
    v_xor_b32 v18, 0x1c0, v18
    v_subrev_u32 v18, 64, v18
    v_lshl_add_u32 v27, v18, 7, v19
    v_mov_b32 v29, 0
    v_mov_b32 v31, 0
    s_max_u32 s87, s61, 4
    s_sub_u32 s87, s87, 4
    s_mul_i32 s88, s87, 37
    s_lshr_b32 s88, s88, 8
    s_lshl2_add_u32 s20, s60, s88
    s_mul_i32 s88, s88, 7
    s_sub_u32 s19, s87, s88
    s_and_b32 s87, s66, 3
    s_mul_i32 s87, s87, 14336
    s_lshl_b32 s88, s19, 7
    s_add_u32 s87, s87, s88
    v_mul_u32_u24 v18, 896, v14
    v_lshlrev_b32 v17, 1, v16
    v_xor_b32 v17, v17, v15
    v_lshl_add_u32 v18, v17, 4, v18
    v_add_u32 v2, s87, v18
    v_add_u32 v3, 6144, v2
    s_lshl_b32 s87, s63, 6
    s_add_u32 s87, s87, s14
    s_lshl4_add_u32 s87, s87, s69
    s_lshl_b32 s88, s87, 11
    s_add_u32 s88, s88, 0x600000
    v_add_u32 v5, s88, v1
    s_lshr_b32 s88, s87, 2
    s_lshl_b32 s88, s88, 5
    s_and_b32 s87, s87, 3
    s_add_u32 s87, s87, s88
    s_lshl2_add_u32 s1, s87, 0x60000
    v_lshrrev_b32 v12, 4, v13
    v_and_b32 v14, 15, v13
    v_bfe_u32 v18, v13, 1, 3
    v_xor_b32 v18, v18, v12
    v_lshlrev_b32 v18, 4, v18
    v_lshl_add_u32 v18, v14, 7, v18
    s_lshl_b32 s87, s3, 12
    s_add_u32 s87, s87, 57344
    v_add_u32 v36, s87, v18
    v_xor_b32 v37, 64, v36
    v_add_u32 v38, 57344, v36
    v_add_u32 v39, 57344, v37
    v_and_b32 v14, 31, v13
    v_lshrrev_b32 v15, 5, v13
    v_bfe_u32 v16, v13, 2, 2
    v_bfe_u32 v17, v13, 4, 1
    v_and_b32 v21, 3, v13
    v_lshrrev_b32 v20, 1, v16
    v_lshl_add_u32 v20, v20, 1, v17
    v_lshlrev_b32 v20, 5, v20
    v_lshl_add_u32 v17, v17, 2, v21
    v_lshl_add_u32 v19, v12, 3, v16
    v_lshlrev_b32 v19, 7, v19
    s_mul_i32 s87, s68, 56
    s_lshl_b32 s88, s68, 3
    s_sub_u32 s88, 120, s88
    v_lshl_add_u32 v18, v21, 3, s87
    v_xor_b32 v44, v18, v20
    v_add_u32 v44, v44, v19
    v_cmp_eq_u32 vcc, 3, v21
    v_add_u32 v18, 32, v18
    v_mov_b32 v45, s88
    v_cndmask_b32 v18, v18, v45, vcc
    v_xor_b32 v18, v18, v20
    v_add_u32 v45, v18, v19
    v_add_u32 v40, 57344, v44
    v_add_u32 v41, 57344, v45
    v_add_u32 v42, 114688, v44
    v_add_u32 v43, 114688, v45
    v_and_b32 v19, 15, v14
    v_add_u32 v19, 4, v19
    v_lshrrev_b32 v19, 4, v19
    v_sub_u32 v18, v14, v19
    v_lshrrev_b32 v19, 4, v14
    v_lshlrev_b32 v19, 1, v19
    v_sub_u32 v18, v18, v19
    v_lshlrev_b32 v19, 3, v15
    v_sub_u32 v19, v18, v19
    v_and_b32 v20, 1, v19
    v_lshlrev_b32 v20, 4, v20
    v_mov_b32 v21, 0x3f80
    v_lshlrev_b32 v20, v20, v21
    v_ashrrev_i32 v19, 1, v19
    v_cmp_eq_u32 vcc, 0, v19
    v_cmp_eq_u32 s[94:95], 1, v19
    s_nop 0
    v_cndmask_b32_e64 v128, 0, v20, vcc
    v_cndmask_b32_e64 v129, 0, v20, s[94:95]
    v_cmp_eq_u32 vcc, 2, v19
    v_cmp_eq_u32 s[94:95], 3, v19
    s_nop 0
    v_cndmask_b32_e64 v130, 0, v20, vcc
    v_cndmask_b32_e64 v131, 0, v20, s[94:95]
    v_cmp_eq_u32 vcc, 8, v19
    v_cmp_eq_u32 s[94:95], 9, v19
    s_nop 0
    v_cndmask_b32_e64 v132, 0, v20, vcc
    v_cndmask_b32_e64 v133, 0, v20, s[94:95]
    v_cmp_eq_u32 vcc, 10, v19
    v_cmp_eq_u32 s[94:95], 11, v19
    s_nop 0
    v_cndmask_b32_e64 v134, 0, v20, vcc
    v_cndmask_b32_e64 v135, 0, v20, s[94:95]
    v_and_b32 v19, 11, v14
    v_cmp_eq_u32 vcc, 11, v19
    v_lshrrev_b32 v19, 4, v14
    v_add_u32 v19, 28, v19
    v_cndmask_b32 v18, v18, v19, vcc
    v_lshl_add_u32 v18, v15, 5, v18
    v_lshlrev_b32 v11, 4, v18
    v_lshl_add_u32 v19, v15, 2, v16
    v_and_b32 v20, 1, v16
    v_lshrrev_b32 v21, 1, v16
    v_sub_u32 v20, v20, v21
    v_lshl_add_u32 v20, v20, 2, v14
    v_mul_u32_u24 v20, 56, v20
    v_lshl_add_u32 v20, v15, 4, v20
    s_mul_i32 s87, s68, 1568
    s_add_u32 s87, s87, 155648
    v_add_u32 v21, s87, v20
    v_mul_u32_u24 v20, 136, v19
    v_lshl_add_u32 v20, v17, 3, v20
    s_mul_i32 s87, s68, 17408
    s_add_u32 s87, s87, 114688
    s_lshl_b32 s88, s67, 6
    s_add_u32 s88, s88, s87
    v_add_u32 v46, s88, v20
    s_mul_i32 s88, s3, 4352
    s_add_u32 s22, s88, s87
    s_lshl2_add_u32 s87, s68, s3
    s_lshl_b32 s87, s87, 11
    s_add_u32 s23, s87, 73728
    v_and_b32 v18, 15, v14
    v_cmp_eq_u32 vcc, 12, v18
    v_mov_b32 v18, 1.0
    s_lshl1_add_u32 s87, s69, s67
    s_lshl_b32 s15, s87, 15
    v_cndmask_b32_e64 v56, 0, v18, vcc
    s_add_u32 s15, s15, 0x500000
    s_lshl_b32 s87, s87, 9
    s_add_u32 s87, s87, 65536
    s_lshr_b32 s88, s65, 2
    s_lshl_b32 s88, s88, 5
    s_and_b32 s89, s65, 3
    s_add_u32 s88, s88, s89
    s_lshl2_add_u32 s0, s88, s87
    s_and_b32 s87, s65, 7
    s_lshl3_add_u32 s87, s62, s87
    s_lshr_b32 s88, s87, 1
    s_lshl_b32 s89, s88, 9
    s_add_u32 s89, s89, 65536
    s_add_u32 s100, s36, s89
    s_addc_u32 s101, s37, 0
    s_lshl_b32 s88, s88, 15
    s_and_b32 s89, s87, 1
    s_lshl_b32 s89, s89, 10
    s_add_u32 s88, s88, s89
    s_add_u32 s16, s88, 0x500000
    s_lshr_b32 s88, s65, 3
    s_lshl_b32 s88, s88, 6
    s_add_u32 s87, s87, s88
    s_lshl_b32 s17, s87, 10
    s_add_u32 s17, s17, 262144
    s_lshl_b32 s87, s87, 7
    s_add_u32 s87, s87, 196608
    s_and_b32 s92, s87, 0xfffffc00
    s_lshl_b32 s89, s89, 9
    s_add_u32 s92, s92, 0
    s_cmp_eq_u32 s66, 7
    s_cselect_b32 s0, s87, s0
    s_lshl2_add_u32 s88, s69, s88
    s_lshl_b32 s18, s88, 10
    s_add_u32 s18, s18, 262144
    s_mov_b32 s24, 49152
    s_mov_b32 s25, 0
    v_mov_b32 v57, v56
    v_mov_b32 v58, v56
    v_mov_b32 v59, v56
    v_mov_b32 v60, v56
    v_mov_b32 v61, v56
    v_mov_b32 v62, v56
    v_mov_b32 v63, v56
    s_bitcmp1_b32 143, s66
    s_cselect_b32 s87, s0, s1
    v_mov_b32 v12, s1
    v_writelane_b32 v12, s87, 1
    v_writelane_b32 v12, s87, 3
    v_and_b32 v13, 2, v0
    v_lshl_add_u32 v12, v13, 18, v12
    s_mov_b64 exec, 3
    buffer_store_dword v29, v12, s[36:39], 0 offen sc1
    s_mov_b64 exec, -1
    v_bfe_u32 v16, v0, 2, 2
    v_and_b32 v17, 3, v0
    s_and_b32 s98, s66, 3
    s_mul_i32 s87, s98, 14336
    v_lshl_add_u32 v17, v17, 3, s87
    v_bfe_u32 v19, v0, 5, 1
    v_bfe_u32 v20, v0, 4, 1
    v_lshl_add_u32 v18, v20, 2, v16
    v_mad_u32_u24 v18, v19, 14, v18
    v_lshl_add_u32 v6, v18, 7, v17
    v_bfe_u32 v18, v18, 1, 2
    v_xor_b32 v18, s98, v18
    v_lshl_add_u32 v6, v18, 5, v6
    v_min_u32 v16, 2, v16
    v_mad_u32_u24 v18, v20, 3, v16
    v_mad_u32_u24 v18, v19, 14, v18
    v_lshl_add_u32 v7, v18, 7, v17
    v_bfe_u32 v18, v18, 1, 2
    v_xor_b32 v18, s98, v18
    v_lshl_add_u32 v7, v18, 5, v7
    s_bfe_u32 s87, s19, 0x10008
    s_xor_b32 s87, s87, s96
    s_lshl1_add_u32 s87, s20, s87
    s_mul_i32 s88, s87, 28672
    s_lshl2_add_u32 s89, s19, s98
    s_lshl_b32 s89, s89, 5
    s_add_u32 s88, s88, s89
    v_and_b32 v16, 31, v0
    v_mul_u32_u24 v16, 896, v16
    v_lshl_add_u32 v16, v19, 4, v16
    v_add_u32 v8, s88, v16
    s_lshl2_add_u32 s87, s87, s98
    s_lshl_b32 s20, s87, 13
    s_add_u32 s20, s20, 0x600000
    s_lshl_b32 s87, s87, 7
    s_add_u32 s87, s87, 393216
    s_and_b32 s19, s19, 1
    s_lshl_b32 s88, s19, 19
    s_add_u32 s87, s87, 0
    s_add_u32 s56, s36, s87
    s_addc_u32 s57, s37, 0
    s_lshl_b32 s64, s19, 15
    s_xor_b32 s70, s64, 32768
    s_add_u32 m0, s72, 97408
    s_nop 0
    buffer_load_dwordx4 v34, s[32:35], s81 offen offset:896 lds
    s_waitcnt lgkmcnt(0)
    s_mul_i32 s26, s26, 1664525
    s_add_u32 s26, s26, 1013904223
    s_or_b32 s26, s26, 1
    s_mov_b32 s27, s26
    s_lshl_b32 s58, s26, 16
    s_mul_i32 s88, s62, 3136
    s_add_u32 s88, s88, s72
    s_cmp_lt_u32 s66, 4
    s_cselect_b32 s88, s88, 0x7f000000
    s_add_u32 m0, s72, 155648
    s_nop 0
    buffer_load_dwordx4 v1, s[52:55], s88 offen lds
    s_waitcnt vmcnt(8)
    v_mov_b32 v30, v28
    ds_write_b128 v27, v[28:31]
    s_waitcnt vmcnt(5)
    s_barrier
    ds_read_b64_tr_b16 v[64:65], v42 offset:32768
    s_add_u32 m0, s71, 106496
    s_nop 0
    buffer_load_dwordx4 v32, s[28:31], s75 offen offset:0 lds
    ds_read_b64_tr_b16 v[66:67], v42 offset:33280
    ds_read_b128 v[144:147], v38 offset:16384
    ds_read_b64_tr_b16 v[68:69], v43 offset:32768
    ds_read_b64_tr_b16 v[70:71], v43 offset:33280
    ds_read_b128 v[148:151], v38 offset:18432
    ds_read_b64_tr_b16 v[72:73], v42 offset:36864
    ds_read_b64_tr_b16 v[74:75], v42 offset:37376
    ds_read_b128 v[152:155], v39 offset:16384
    buffer_load_dwordx4 v33, s[28:31], s75 offen offset:1024 lds
    ds_read_b64_tr_b16 v[76:77], v43 offset:36864
    ds_read_b64_tr_b16 v[78:79], v43 offset:37376
    ds_read_b128 v[156:159], v39 offset:18432
    s_add_u32 m0, s72, 121984
    s_nop 0
    buffer_load_dwordx4 v34, s[32:35], s82 offen offset:896 lds
    s_waitcnt vmcnt(4) lgkmcnt(0)
    s_barrier
    v_mfma_f32_16x16x32_bf16 v[96:99], v[64:67], v[144:147], 0
    ds_read_b64_tr_b16 v[80:81], v40 offset:40960
    s_add_u32 m0, s71, 131072
    s_nop 0
    buffer_load_dwordx4 v32, s[28:31], s76 offen offset:0 lds
    ds_read_b64_tr_b16 v[82:83], v40 offset:41472
    ds_read_b128 v[160:163], v36 offset:24576
    v_mfma_f32_16x16x32_bf16 v[104:107], v[68:71], v[144:147], 0
    ds_read_b64_tr_b16 v[84:85], v41 offset:40960
    ds_read_b64_tr_b16 v[86:87], v41 offset:41472
    v_mfma_f32_16x16x32_bf16 v[108:111], v[68:71], v[148:151], 0
    ds_read_b128 v[164:167], v36 offset:26624
    ds_read_b64_tr_b16 v[88:89], v40 offset:45056
    ds_read_b64_tr_b16 v[90:91], v40 offset:45568
    v_mfma_f32_16x16x32_bf16 v[100:103], v[64:67], v[148:151], 0
    ds_read_b128 v[168:171], v37 offset:24576
    buffer_load_dwordx4 v33, s[28:31], s76 offen offset:1024 lds
    ds_read_b64_tr_b16 v[92:93], v41 offset:45056
    v_mfma_f32_16x16x32_bf16 v[96:99], v[72:75], v[152:155], v[96:99]
    ds_read_b64_tr_b16 v[94:95], v41 offset:45568
    ds_read_b128 v[172:175], v37 offset:26624
    s_add_u32 m0, s72, 146560
    s_nop 0
    buffer_load_dwordx4 v34, s[32:35], s83 offen offset:896 lds
    v_mfma_f32_16x16x32_bf16 v[104:107], v[76:79], v[152:155], v[104:107]
    v_mfma_f32_16x16x32_bf16 v[108:111], v[76:79], v[156:159], v[108:111]
    v_mfma_f32_16x16x32_bf16 v[100:103], v[72:75], v[156:159], v[100:103]
    s_waitcnt vmcnt(3) lgkmcnt(0)
    s_barrier
    ds_read_b64 v[136:137], v21 offset:0
    ds_read_b64 v[138:139], v21 offset:8
    ds_read_b64 v[140:141], v21 offset:32
    ds_read_b64 v[142:143], v21 offset:40
    v_mfma_f32_16x16x32_bf16 v[96:99], v[80:83], v[160:163], v[96:99]
    ds_read_b64_tr_b16 v[64:65], v42 offset:8192
    s_add_u32 m0, s71, 81920
    s_nop 0
    buffer_load_dwordx4 v32, s[28:31], s77 offen offset:0 lds
    s_lshl1_add_u32 s87, s14, s68
    s_mul_i32 s87, s87, 3136
    s_and_b32 s87, s87, 0xffffff80
    s_bitcmp1_b32 0x81, s62
    s_cselect_b32 s87, s87, 0x7f000000
    v_bfe_u32 v12, v0, 1, 5
    v_min_u32 v12, 24, v12
    v_lshlrev_b32 v12, 7, v12
    s_cmp_eq_u32 s62, 7
    s_cselect_b32 s52, s44, s40
    s_cselect_b32 s53, s45, s41
    s_mov_b32 s54, 401408
    buffer_load_dword v22, v12, s[52:55], s87 offen
    ds_read_b64_tr_b16 v[66:67], v42 offset:8704
    ds_read_b128 v[176:179], v36 offset:49152
    v_mfma_f32_16x16x32_bf16 v[104:107], v[84:87], v[160:163], v[104:107]
    ds_read_b64_tr_b16 v[68:69], v43 offset:8192
    ds_read_b64_tr_b16 v[70:71], v43 offset:8704
    v_mfma_f32_16x16x32_bf16 v[108:111], v[84:87], v[164:167], v[108:111]
    ds_read_b128 v[180:183], v36 offset:51200
    ds_read_b64_tr_b16 v[72:73], v42 offset:12288
    ds_read_b64_tr_b16 v[74:75], v42 offset:12800
    v_mfma_f32_16x16x32_bf16 v[100:103], v[80:83], v[164:167], v[100:103]
    ds_read_b128 v[184:187], v37 offset:49152
    buffer_load_dwordx4 v33, s[28:31], s77 offen offset:1024 lds
    ds_read_b64_tr_b16 v[76:77], v43 offset:12288
    v_mfma_f32_16x16x32_bf16 v[96:99], v[88:91], v[168:171], v[96:99]
    ds_read_b64_tr_b16 v[78:79], v43 offset:12800
    ds_read_b128 v[188:191], v37 offset:51200
    s_add_u32 m0, s72, 97408
    s_nop 0
    buffer_load_dwordx4 v34, s[32:35], s84 offen offset:896 lds
    v_mfma_f32_16x16x32_bf16 v[104:107], v[92:95], v[168:171], v[104:107]
    v_mfma_f32_16x16x32_bf16 v[108:111], v[92:95], v[172:175], v[108:111]
    v_mfma_f32_16x16x32_bf16 v[100:103], v[88:91], v[172:175], v[100:103]
    s_waitcnt vmcnt(4) lgkmcnt(0)
    s_barrier
    v_mfma_f32_16x16x32_bf16 v[96:99], v[64:67], v[176:179], v[96:99]
    ds_read_b64_tr_b16 v[80:81], v42 offset:32768
    s_add_u32 m0, s71, 106496
    s_nop 0
    buffer_load_dwordx4 v32, s[28:31], s78 offen offset:0 lds
    v_mfma_f32_32x32x16_bf16 v[112:127], v[136:139], v[128:131], 0
    ds_read_b64_tr_b16 v[82:83], v42 offset:33280
    ds_read_b128 v[192:195], v38 offset:16384
    v_mfma_f32_16x16x32_bf16 v[104:107], v[68:71], v[176:179], v[104:107]
    ds_read_b64_tr_b16 v[84:85], v43 offset:32768
    ds_read_b64_tr_b16 v[86:87], v43 offset:33280
    v_mfma_f32_16x16x32_bf16 v[108:111], v[68:71], v[180:183], v[108:111]
    ds_read_b128 v[196:199], v38 offset:18432
    ds_read_b64_tr_b16 v[88:89], v42 offset:36864
    ds_read_b64_tr_b16 v[90:91], v42 offset:37376
    v_mfma_f32_16x16x32_bf16 v[100:103], v[64:67], v[180:183], v[100:103]
    ds_read_b128 v[200:203], v39 offset:16384
    buffer_load_dwordx4 v33, s[28:31], s78 offen offset:1024 lds
    ds_read_b64_tr_b16 v[92:93], v43 offset:36864
    v_mfma_f32_16x16x32_bf16 v[96:99], v[72:75], v[184:187], v[96:99]
    ds_read_b64_tr_b16 v[94:95], v43 offset:37376
    v_mfma_f32_32x32x16_bf16 v[112:127], v[140:143], v[132:135], v[112:127]
    ds_read_b128 v[204:207], v39 offset:18432
    s_add_u32 m0, s72, 121984
    s_nop 0
    buffer_load_dwordx4 v34, s[32:35], s85 offen offset:896 lds
    v_mfma_f32_16x16x32_bf16 v[104:107], v[76:79], v[184:187], v[104:107]
    v_mfma_f32_16x16x32_bf16 v[108:111], v[76:79], v[188:191], v[108:111]
    v_mfma_f32_16x16x32_bf16 v[100:103], v[72:75], v[188:191], v[100:103]
    s_waitcnt vmcnt(3) lgkmcnt(0)
    s_barrier
    v_mfma_f32_16x16x32_bf16 v[96:99], v[80:83], v[192:195], v[96:99]
    ds_read_b64_tr_b16 v[64:65], v40 offset:40960
    s_add_u32 m0, s71, 131072
    s_nop 0
    buffer_load_dwordx4 v32, s[28:31], s79 offen offset:0 lds
    v_mul_f32 v112, 0x3fb8aa3b, v112
    v_mul_f32 v113, 0x3fb8aa3b, v113
    ds_read_b64_tr_b16 v[66:67], v40 offset:41472
    v_cvt_pk_bf16_f32 v24, v112, v113
    ds_read_b128 v[208:211], v36 offset:24576
    v_mfma_f32_16x16x32_bf16 v[104:107], v[84:87], v[192:195], v[104:107]
    v_mul_f32 v114, 0x3fb8aa3b, v114
    ds_read_b64_tr_b16 v[68:69], v41 offset:40960
    v_mul_f32 v115, 0x3fb8aa3b, v115
    ds_read_b64_tr_b16 v[70:71], v41 offset:41472
    v_cvt_pk_bf16_f32 v25, v114, v115
    v_mfma_f32_16x16x32_bf16 v[108:111], v[84:87], v[196:199], v[108:111]
    ds_read_b128 v[212:215], v36 offset:26624
    v_mul_f32 v116, 0x3fb8aa3b, v116
    v_mul_f32 v117, 0x3fb8aa3b, v117
    ds_read_b64_tr_b16 v[72:73], v40 offset:45056
    v_cvt_pk_bf16_f32 v26, v116, v117
    ds_read_b64_tr_b16 v[74:75], v40 offset:45568
    v_mfma_f32_16x16x32_bf16 v[100:103], v[80:83], v[196:199], v[100:103]
    v_mul_f32 v118, 0x3fb8aa3b, v118
    ds_read_b128 v[216:219], v37 offset:24576
    buffer_load_dwordx4 v33, s[28:31], s79 offen offset:1024 lds
    v_mul_f32 v119, 0x3fb8aa3b, v119
    ds_read_b64_tr_b16 v[76:77], v41 offset:45056
    v_cvt_pk_bf16_f32 v27, v118, v119
    v_mfma_f32_16x16x32_bf16 v[96:99], v[88:91], v[200:203], v[96:99]
    ds_read_b64_tr_b16 v[78:79], v41 offset:45568
    v_mul_f32 v120, 0x3fb8aa3b, v120
    v_mul_f32 v121, 0x3fb8aa3b, v121
    ds_read_b128 v[220:223], v37 offset:26624
    v_cvt_pk_bf16_f32 v28, v120, v121
    s_add_u32 m0, s72, 146560
    s_nop 0
    buffer_load_dwordx4 v34, s[32:35], s86 offen offset:896 lds
    v_mfma_f32_16x16x32_bf16 v[104:107], v[92:95], v[200:203], v[104:107]
    v_mul_f32 v122, 0x3fb8aa3b, v122
    v_mul_f32 v123, 0x3fb8aa3b, v123
    v_cvt_pk_bf16_f32 v29, v122, v123
    v_mfma_f32_16x16x32_bf16 v[108:111], v[92:95], v[204:207], v[108:111]
    v_mul_f32 v124, 0x3fb8aa3b, v124
    v_mul_f32 v125, 0x3fb8aa3b, v125
    v_cvt_pk_bf16_f32 v30, v124, v125
    v_mfma_f32_16x16x32_bf16 v[100:103], v[88:91], v[204:207], v[100:103]
    v_mul_f32 v126, 0x3fb8aa3b, v126
    v_mul_f32 v127, 0x3fb8aa3b, v127
    v_cvt_pk_bf16_f32 v31, v126, v127
    s_waitcnt vmcnt(3) lgkmcnt(0)
    s_barrier
    v_mfma_f32_16x16x32_bf16 v[96:99], v[64:67], v[208:211], v[96:99]
    ds_read_b64_tr_b16 v[80:81], v42 offset:8192
    s_add_u32 m0, s72, 55552
    s_nop 0
    buffer_load_dwordx4 v34, s[32:35], s80 offen offset:1792 lds
    s_add_u32 m0, s72, 49152
    s_mov_b64 exec, s[8:9]
    buffer_load_dwordx4 v35, s[32:35], s80 offen offset:0 lds
    s_mov_b64 exec, -1
    ds_read_b64_tr_b16 v[82:83], v42 offset:8704
    ds_read_b128 v[224:227], v36 offset:49152
    v_mfma_f32_16x16x32_bf16 v[104:107], v[68:71], v[208:211], v[104:107]
    ds_read_b64_tr_b16 v[84:85], v43 offset:8192
    ds_read_b64_tr_b16 v[86:87], v43 offset:8704
    v_mfma_f32_16x16x32_bf16 v[108:111], v[68:71], v[212:215], v[108:111]
    ds_read_b128 v[228:231], v36 offset:51200
    ds_read_b64_tr_b16 v[88:89], v42 offset:12288
    ds_read_b64_tr_b16 v[90:91], v42 offset:12800
    v_mfma_f32_16x16x32_bf16 v[100:103], v[64:67], v[212:215], v[100:103]
    ds_read_b128 v[232:235], v37 offset:49152
    ds_read_b64_tr_b16 v[92:93], v43 offset:12288
    v_mfma_f32_16x16x32_bf16 v[96:99], v[72:75], v[216:219], v[96:99]
    ds_read_b64_tr_b16 v[94:95], v43 offset:12800
    ds_read_b128 v[236:239], v37 offset:51200
    v_mfma_f32_16x16x32_bf16 v[104:107], v[76:79], v[216:219], v[104:107]
    v_mfma_f32_16x16x32_bf16 v[108:111], v[76:79], v[220:223], v[108:111]
    v_mfma_f32_16x16x32_bf16 v[100:103], v[72:75], v[220:223], v[100:103]
    s_waitcnt vmcnt(2) lgkmcnt(0)
    s_barrier
    v_mfma_f32_16x16x32_bf16 v[96:99], v[80:83], v[224:227], v[96:99]
    ds_read_b64_tr_b16 v[64:65], v42 offset:32768
    v_and_b32 v32, 31, v0
    ds_read_b64_tr_b16 v[66:67], v42 offset:33280
    v_mfma_f32_16x16x32_bf16 v[104:107], v[84:87], v[224:227], v[104:107]
    v_bfe_u32 v33, v0, 5, 1
    ds_read_b128 v[240:243], v38 offset:16384
    v_mfma_f32_16x16x32_bf16 v[108:111], v[84:87], v[228:231], v[108:111]
    ds_read_b64_tr_b16 v[68:69], v43 offset:32768
    v_mul_u32_u24 v32, 136, v32
    ds_read_b64_tr_b16 v[70:71], v43 offset:33280
    v_mfma_f32_16x16x32_bf16 v[100:103], v[80:83], v[228:231], v[100:103]
    ds_read_b128 v[244:247], v38 offset:18432
    v_lshl_add_u32 v32, v33, 3, v32
    v_mfma_f32_16x16x32_bf16 v[96:99], v[88:91], v[232:235], v[96:99]
    ds_read_b64_tr_b16 v[72:73], v42 offset:36864
    v_add_u32 v32, s22, v32
    ds_read_b64_tr_b16 v[74:75], v42 offset:37376
    v_mfma_f32_16x16x32_bf16 v[104:107], v[92:95], v[232:235], v[104:107]
    ds_read_b128 v[248:251], v39 offset:16384
    v_and_b32 v33, 0x300, v1
    v_mfma_f32_16x16x32_bf16 v[108:111], v[92:95], v[236:239], v[108:111]
    ds_read_b64_tr_b16 v[76:77], v43 offset:36864
    ds_read_b64_tr_b16 v[78:79], v43 offset:37376
    v_add3_u32 v33, v33, s23, v1
    v_mfma_f32_16x16x32_bf16 v[100:103], v[88:91], v[236:239], v[100:103]
    ds_read_b128 v[252:255], v39 offset:18432
    s_waitcnt lgkmcnt(0)
    s_barrier
    v_mfma_f32_16x16x32_bf16 v[96:99], v[64:67], v[240:243], v[96:99]
    v_mfma_f32_16x16x32_bf16 v[104:107], v[68:71], v[240:243], v[104:107]
    v_mfma_f32_16x16x32_bf16 v[108:111], v[68:71], v[244:247], v[108:111]
    v_mfma_f32_16x16x32_bf16 v[100:103], v[64:67], v[244:247], v[100:103]
    v_mfma_f32_16x16x32_bf16 v[96:99], v[72:75], v[248:251], v[96:99]
    v_mfma_f32_16x16x32_bf16 v[104:107], v[76:79], v[248:251], v[104:107]
    v_mfma_f32_16x16x32_bf16 v[108:111], v[76:79], v[252:255], v[108:111]
    v_mfma_f32_16x16x32_bf16 v[100:103], v[72:75], v[252:255], v[100:103]
    s_nop 4
    v_cvt_pk_bf16_f32 v64, v96, v97
    v_cvt_pk_bf16_f32 v65, v98, v99
    s_nop 0
    v_cvt_pk_bf16_f32 v66, v100, v101
    v_cvt_pk_bf16_f32 v67, v102, v103
    v_cvt_pk_bf16_f32 v68, v104, v105
    v_cvt_pk_bf16_f32 v69, v106, v107
    v_cvt_pk_bf16_f32 v70, v108, v109
    v_cvt_pk_bf16_f32 v71, v110, v111
    v_permlane16_swap_b32 v64, v66
    v_permlane16_swap_b32 v65, v67
    v_permlane16_swap_b32 v68, v70
    v_permlane16_swap_b32 v69, v71
    v_mfma_f32_32x32x16_bf16 v[112:127], v[24:27], v[64:67], 0
    s_nop 0
    v_mfma_f32_32x32x16_bf16 v[112:127], v[28:31], v[68:71], v[112:127]
    s_cmp_eq_u32 s96, 1
    s_cbranch_scc1 L_A1
    s_setprio 1
    s_add_u32 m0, s72, 63744
    s_nop 0
    buffer_load_dwordx4 v34, s[32:35], s81 offen offset:1792 lds
    s_add_u32 m0, s72, 71936
    s_nop 0
    buffer_load_dwordx4 v34, s[32:35], s82 offen offset:1792 lds
    s_nop 2
    v_exp_f32_e64 v128, -v112
    v_exp_f32 v112, v112
    v_exp_f32_e64 v129, -v113
    v_exp_f32 v113, v113
    v_exp_f32_e64 v130, -v114
    v_exp_f32 v114, v114
    v_exp_f32_e64 v131, -v115
    v_exp_f32 v115, v115
    v_exp_f32_e64 v132, -v116
    v_exp_f32 v116, v116
    v_exp_f32_e64 v133, -v117
    v_exp_f32 v117, v117
    v_exp_f32_e64 v134, -v118
    v_exp_f32 v118, v118
    v_exp_f32_e64 v135, -v126
    v_exp_f32 v119, v126
    v_exp_f32_e64 v136, -v120
    v_exp_f32 v120, v120
    v_exp_f32_e64 v137, -v121
    v_exp_f32 v121, v121
    v_exp_f32_e64 v138, -v122
    v_exp_f32 v122, v122
    v_exp_f32_e64 v139, -v123
    v_exp_f32 v123, v123
    v_exp_f32_e64 v140, -v124
    v_exp_f32 v124, v124
    v_exp_f32_e64 v141, -v125
    v_exp_f32 v125, v125
    v_pk_add_f32 v[18:19], v[112:113], v[114:115]
    v_pk_add_f32 v[20:21], v[128:129], v[130:131]
    v_pk_add_f32 v[18:19], v[18:19], v[116:117]
    v_pk_add_f32 v[20:21], v[20:21], v[132:133]
    v_pk_add_f32 v[18:19], v[18:19], v[118:119]
    v_pk_add_f32 v[20:21], v[20:21], v[134:135]
    v_pk_add_f32 v[18:19], v[18:19], v[120:121]
    v_pk_add_f32 v[20:21], v[20:21], v[136:137]
    v_pk_add_f32 v[18:19], v[18:19], v[122:123]
    v_pk_add_f32 v[20:21], v[20:21], v[138:139]
    v_pk_add_f32 v[18:19], v[18:19], v[124:125]
    v_pk_add_f32 v[20:21], v[20:21], v[140:141]
    v_add_f32 v12, v18, v19
    v_add_f32 v13, v20, v21
    s_nop 1
    v_permlane32_swap_b32 v12, v13
    v_add_f32 v12, v12, v13
    v_subrev_u32 v13, 0xf800000, v12
    v_cmp_le_u32 vcc, 0x6c000000, v13
    s_mov_b32 s98, 0
    s_cbranch_vccnz L_phixk
L_phir_k0:
    v_rcp_f32 v14, v12
    s_nop 0
    v_mov_b32 v16, v14
    s_nop 1
    v_permlane32_swap_b32 v14, v16
    v_pk_mul_f32 v[112:113], v[112:113], v[14:15] op_sel_hi:[1,0]
    v_cvt_pk_bf16_f32 v96, v112, v113
    v_pk_mul_f32 v[128:129], v[128:129], v[16:17] op_sel_hi:[1,0]
    v_cvt_pk_bf16_f32 v104, v128, v129
    v_pk_mul_f32 v[114:115], v[114:115], v[14:15] op_sel_hi:[1,0]
    v_cvt_pk_bf16_f32 v97, v114, v115
    v_pk_mul_f32 v[130:131], v[130:131], v[16:17] op_sel_hi:[1,0]
    v_cvt_pk_bf16_f32 v105, v130, v131
    ds_write_b64 v32, v[96:97] offset:0
    ds_write_b64 v32, v[104:105] offset:64
    v_pk_mul_f32 v[116:117], v[116:117], v[14:15] op_sel_hi:[1,0]
    v_cvt_pk_bf16_f32 v98, v116, v117
    v_pk_mul_f32 v[132:133], v[132:133], v[16:17] op_sel_hi:[1,0]
    v_cvt_pk_bf16_f32 v106, v132, v133
    v_pk_mul_f32 v[118:119], v[118:119], v[14:15] op_sel_hi:[1,0]
    v_cvt_pk_bf16_f32 v99, v118, 0
    v_pk_mul_f32 v[134:135], v[134:135], v[16:17] op_sel_hi:[1,0]
    v_cvt_pk_bf16_f32 v107, v134, 0
    ds_write_b64 v32, v[98:99] offset:16
    ds_write_b64 v32, v[106:107] offset:80
    v_pk_mul_f32 v[120:121], v[120:121], v[14:15] op_sel_hi:[1,0]
    v_cvt_pk_bf16_f32 v100, v120, v121
    v_pk_mul_f32 v[136:137], v[136:137], v[16:17] op_sel_hi:[1,0]
    v_cvt_pk_bf16_f32 v108, v136, v137
    v_pk_mul_f32 v[122:123], v[122:123], v[14:15] op_sel_hi:[1,0]
    v_cvt_pk_bf16_f32 v101, v122, v123
    v_pk_mul_f32 v[138:139], v[138:139], v[16:17] op_sel_hi:[1,0]
    v_cvt_pk_bf16_f32 v109, v138, v139
    ds_write_b64 v32, v[100:101] offset:32
    ds_write_b64 v32, v[108:109] offset:96
    v_pk_mul_f32 v[124:125], v[124:125], v[14:15] op_sel_hi:[1,0]
    v_cvt_pk_bf16_f32 v102, v124, v125
    v_pk_mul_f32 v[140:141], v[140:141], v[16:17] op_sel_hi:[1,0]
    v_cvt_pk_bf16_f32 v110, v140, v141
    v_cvt_pk_bf16_f32 v103, v119, 0
    v_cvt_pk_bf16_f32 v111, v135, 0
    ds_write_b64 v32, v[102:103] offset:48
    ds_write_b64 v32, v[110:111] offset:112
    s_add_u32 m0, s72, 80128
    s_add_u32 s99, s83, 86016
    buffer_load_dwordx4 v34, s[32:35], s83 offen offset:1792 lds
    s_add_u32 m0, s72, 84224
    s_nop 0
    buffer_load_dwordx4 v34, s[32:35], s99 offen offset:1792 lds
    s_add_u32 m0, s72, 88320
    s_add_u32 s99, s84, 86016
    buffer_load_dwordx4 v34, s[32:35], s84 offen offset:1792 lds
    s_add_u32 m0, s72, 92416
    s_nop 0
    buffer_load_dwordx4 v34, s[32:35], s99 offen offset:1792 lds
    s_setprio 0
    s_waitcnt vmcnt(4)
    s_barrier
    ds_read_b64_tr_b16 v[80:81], v40 offset:0
    s_add_u32 m0, s72, 96512
    s_nop 0
    buffer_load_dwordx4 v34, s[32:35], s85 offen offset:1792 lds
    ds_read_b64_tr_b16 v[82:83], v40 offset:512
    ds_read_b64_tr_b16 v[84:85], v41 offset:0
    ds_read_b64_tr_b16 v[86:87], v41 offset:512
    ds_read_b64_tr_b16 v[88:89], v40 offset:4096
    s_add_u32 m0, s72, 104704
    s_nop 0
    buffer_load_dwordx4 v34, s[32:35], s86 offen offset:1792 lds
    ds_read_b64_tr_b16 v[90:91], v40 offset:4608
    ds_read_b64_tr_b16 v[92:93], v41 offset:4096
    ds_read_b64_tr_b16 v[94:95], v41 offset:4608
    s_waitcnt lgkmcnt(6)
    v_mfma_f32_16x16x32_bf16 v[48:51], v[144:147], v[80:83], 0
    ds_read_b64_tr_b16 v[64:65], v40 offset:8192
    s_add_u32 m0, s72, 40960
    s_mov_b64 exec, s[8:9]
    buffer_load_dwordx4 v35, s[32:35], s81 offen offset:0 lds
    s_mov_b64 exec, -1
    s_waitcnt lgkmcnt(5)
    v_mfma_f32_16x16x32_bf16 v[56:59], v[144:147], v[84:87], v[56:59]
    ds_read_b64_tr_b16 v[66:67], v40 offset:8704
    v_mfma_f32_16x16x32_bf16 v[60:63], v[148:151], v[84:87], v[60:63]
    ds_read_b64_tr_b16 v[68:69], v41 offset:8192
    v_mfma_f32_16x16x32_bf16 v[52:55], v[148:151], v[80:83], 0
    ds_read_b64_tr_b16 v[70:71], v41 offset:8704
    s_waitcnt lgkmcnt(6)
    v_mfma_f32_16x16x32_bf16 v[48:51], v[152:155], v[88:91], v[48:51]
    ds_read_b64_tr_b16 v[72:73], v40 offset:12288
    s_waitcnt lgkmcnt(5)
    v_mfma_f32_16x16x32_bf16 v[56:59], v[152:155], v[92:95], v[56:59]
    ds_read_b64_tr_b16 v[74:75], v40 offset:12800
    v_mfma_f32_16x16x32_bf16 v[60:63], v[156:159], v[92:95], v[60:63]
    ds_read_b64_tr_b16 v[76:77], v41 offset:12288
    v_mfma_f32_16x16x32_bf16 v[52:55], v[156:159], v[88:91], v[52:55]
    ds_read_b64_tr_b16 v[78:79], v41 offset:12800
    s_waitcnt lgkmcnt(6)
    v_mfma_f32_16x16x32_bf16 v[48:51], v[160:163], v[64:67], v[48:51]
    ds_read_b64_tr_b16 v[80:81], v40 offset:16384
    s_add_u32 m0, s72, 32768
    s_mov_b64 exec, s[8:9]
    buffer_load_dwordx4 v35, s[32:35], s82 offen offset:0 lds
    s_mov_b64 exec, -1
    ds_read_b64_tr_b16 v[82:83], v40 offset:16896
    s_waitcnt lgkmcnt(6)
    v_mfma_f32_16x16x32_bf16 v[56:59], v[160:163], v[68:71], v[56:59]
    ds_read_b64_tr_b16 v[84:85], v41 offset:16384
    ds_read_b64_tr_b16 v[86:87], v41 offset:16896
    v_mfma_f32_16x16x32_bf16 v[60:63], v[164:167], v[68:71], v[60:63]
    ds_read_b64_tr_b16 v[88:89], v40 offset:20480
    v_mfma_f32_16x16x32_bf16 v[52:55], v[164:167], v[64:67], v[52:55]
    ds_read_b64_tr_b16 v[90:91], v40 offset:20992
    ds_read_b64_tr_b16 v[92:93], v41 offset:20480
    s_waitcnt lgkmcnt(9)
    v_mfma_f32_16x16x32_bf16 v[48:51], v[168:171], v[72:75], v[48:51]
    ds_read_b64_tr_b16 v[94:95], v41 offset:20992
    s_waitcnt lgkmcnt(8)
    v_mfma_f32_16x16x32_bf16 v[56:59], v[168:171], v[76:79], v[56:59]
    v_mfma_f32_16x16x32_bf16 v[60:63], v[172:175], v[76:79], v[60:63]
    v_mfma_f32_16x16x32_bf16 v[52:55], v[172:175], v[72:75], v[52:55]
    s_waitcnt vmcnt(4) lgkmcnt(0)
    s_barrier
    v_mfma_f32_16x16x32_bf16 v[48:51], v[176:179], v[80:83], v[48:51]
    ds_read_b64_tr_b16 v[64:65], v40 offset:24576
    s_add_u32 m0, s72, 24576
    s_mov_b64 exec, s[8:9]
    buffer_load_dwordx4 v35, s[32:35], s83 offen offset:0 lds
    s_mov_b64 exec, -1
    v_mfma_f32_16x16x32_bf16 v[56:59], v[176:179], v[84:87], v[56:59]
    ds_read_b64_tr_b16 v[66:67], v40 offset:25088
    v_mfma_f32_16x16x32_bf16 v[60:63], v[180:183], v[84:87], v[60:63]
    ds_read_b64_tr_b16 v[68:69], v41 offset:24576
    v_mfma_f32_16x16x32_bf16 v[52:55], v[180:183], v[80:83], v[52:55]
    ds_read_b64_tr_b16 v[70:71], v41 offset:25088
    v_mfma_f32_16x16x32_bf16 v[48:51], v[184:187], v[88:91], v[48:51]
    ds_read_b64_tr_b16 v[72:73], v40 offset:28672
    v_mfma_f32_16x16x32_bf16 v[56:59], v[184:187], v[92:95], v[56:59]
    ds_read_b64_tr_b16 v[74:75], v40 offset:29184
    v_mfma_f32_16x16x32_bf16 v[60:63], v[188:191], v[92:95], v[60:63]
    ds_read_b64_tr_b16 v[76:77], v41 offset:28672
    v_mfma_f32_16x16x32_bf16 v[52:55], v[188:191], v[88:91], v[52:55]
    ds_read_b64_tr_b16 v[78:79], v41 offset:29184
    s_waitcnt lgkmcnt(6)
    v_mfma_f32_16x16x32_bf16 v[48:51], v[192:195], v[64:67], v[48:51]
    ds_read_b64_tr_b16 v[80:81], v40 offset:32768
    s_add_u32 m0, s72, 16384
    s_mov_b64 exec, s[8:9]
    buffer_load_dwordx4 v35, s[32:35], s84 offen offset:0 lds
    s_mov_b64 exec, -1
    ds_read_b64_tr_b16 v[82:83], v40 offset:33280
    s_waitcnt lgkmcnt(6)
    v_mfma_f32_16x16x32_bf16 v[56:59], v[192:195], v[68:71], v[56:59]
    ds_read_b64_tr_b16 v[84:85], v41 offset:32768
    ds_read_b64_tr_b16 v[86:87], v41 offset:33280
    v_mfma_f32_16x16x32_bf16 v[60:63], v[196:199], v[68:71], v[60:63]
    ds_read_b64_tr_b16 v[88:89], v40 offset:36864
    v_mfma_f32_16x16x32_bf16 v[52:55], v[196:199], v[64:67], v[52:55]
    ds_read_b64_tr_b16 v[90:91], v40 offset:37376
    ds_read_b64_tr_b16 v[92:93], v41 offset:36864
    s_waitcnt lgkmcnt(9)
    v_mfma_f32_16x16x32_bf16 v[48:51], v[200:203], v[72:75], v[48:51]
    ds_read_b64_tr_b16 v[94:95], v41 offset:37376
    s_waitcnt lgkmcnt(8)
    v_mfma_f32_16x16x32_bf16 v[56:59], v[200:203], v[76:79], v[56:59]
    v_mfma_f32_16x16x32_bf16 v[60:63], v[204:207], v[76:79], v[60:63]
    v_mfma_f32_16x16x32_bf16 v[52:55], v[204:207], v[72:75], v[52:55]
    s_waitcnt vmcnt(4) lgkmcnt(0)
    s_barrier
    v_mfma_f32_16x16x32_bf16 v[48:51], v[208:211], v[80:83], v[48:51]
    ds_read_b64_tr_b16 v[64:65], v40 offset:40960
    s_add_u32 m0, s72, 8192
    s_mov_b64 exec, s[8:9]
    buffer_load_dwordx4 v35, s[32:35], s85 offen offset:0 lds
    s_mov_b64 exec, -1
    v_mfma_f32_16x16x32_bf16 v[56:59], v[208:211], v[84:87], v[56:59]
    ds_read_b64_tr_b16 v[66:67], v40 offset:41472
    v_mfma_f32_16x16x32_bf16 v[60:63], v[212:215], v[84:87], v[60:63]
    ds_read_b64_tr_b16 v[68:69], v41 offset:40960
    v_mfma_f32_16x16x32_bf16 v[52:55], v[212:215], v[80:83], v[52:55]
    ds_read_b64_tr_b16 v[70:71], v41 offset:41472
    v_mfma_f32_16x16x32_bf16 v[48:51], v[216:219], v[88:91], v[48:51]
    ds_read_b64_tr_b16 v[72:73], v40 offset:45056
    v_mfma_f32_16x16x32_bf16 v[56:59], v[216:219], v[92:95], v[56:59]
    ds_read_b64_tr_b16 v[74:75], v40 offset:45568
    v_mfma_f32_16x16x32_bf16 v[60:63], v[220:223], v[92:95], v[60:63]
    ds_read_b64_tr_b16 v[76:77], v41 offset:45056
    v_mfma_f32_16x16x32_bf16 v[52:55], v[220:223], v[88:91], v[52:55]
    ds_read_b64_tr_b16 v[78:79], v41 offset:45568
    s_waitcnt lgkmcnt(6)
    v_mfma_f32_16x16x32_bf16 v[48:51], v[224:227], v[64:67], v[48:51]
    ds_read_b64_tr_b16 v[80:81], v40 offset:49152
    s_add_u32 m0, s72, 0
    s_mov_b64 exec, s[8:9]
    buffer_load_dwordx4 v35, s[32:35], s86 offen offset:0 lds
    s_mov_b64 exec, -1
    s_waitcnt lgkmcnt(5)
    v_mfma_f32_16x16x32_bf16 v[56:59], v[224:227], v[68:71], v[56:59]
    ds_read_b64_tr_b16 v[82:83], v40 offset:49664
    v_mfma_f32_16x16x32_bf16 v[60:63], v[228:231], v[68:71], v[60:63]
    ds_read_b64_tr_b16 v[84:85], v41 offset:49152
    v_mfma_f32_16x16x32_bf16 v[52:55], v[228:231], v[64:67], v[52:55]
    ds_read_b64_tr_b16 v[86:87], v41 offset:49664
    s_waitcnt lgkmcnt(6)
    v_mfma_f32_16x16x32_bf16 v[48:51], v[232:235], v[72:75], v[48:51]
    ds_read_b64_tr_b16 v[88:89], v40 offset:53248
    s_waitcnt lgkmcnt(5)
    v_mfma_f32_16x16x32_bf16 v[56:59], v[232:235], v[76:79], v[56:59]
    ds_read_b64_tr_b16 v[90:91], v40 offset:53760
    v_mfma_f32_16x16x32_bf16 v[60:63], v[236:239], v[76:79], v[60:63]
    ds_read_b64_tr_b16 v[92:93], v41 offset:53248
    v_mfma_f32_16x16x32_bf16 v[52:55], v[236:239], v[72:75], v[52:55]
    ds_read_b64_tr_b16 v[94:95], v41 offset:53760
    s_waitcnt lgkmcnt(6)
    v_mfma_f32_16x16x32_bf16 v[48:51], v[240:243], v[80:83], v[48:51]
    ds_read_b64_tr_b16 v[64:65], v44 offset:49152
    s_waitcnt lgkmcnt(5)
    v_mfma_f32_16x16x32_bf16 v[56:59], v[240:243], v[84:87], v[56:59]
    ds_read_b64_tr_b16 v[66:67], v44 offset:49664
    v_mfma_f32_16x16x32_bf16 v[60:63], v[244:247], v[84:87], v[60:63]
    ds_read_b64_tr_b16 v[68:69], v45 offset:49152
    v_mfma_f32_16x16x32_bf16 v[52:55], v[244:247], v[80:83], v[52:55]
    ds_read_b64_tr_b16 v[70:71], v45 offset:49664
    s_waitcnt lgkmcnt(6)
    v_mfma_f32_16x16x32_bf16 v[48:51], v[248:251], v[88:91], v[48:51]
    ds_read_b64_tr_b16 v[72:73], v44 offset:53248
    s_waitcnt lgkmcnt(5)
    v_mfma_f32_16x16x32_bf16 v[56:59], v[248:251], v[92:95], v[56:59]
    ds_read_b64_tr_b16 v[74:75], v44 offset:53760
    v_mfma_f32_16x16x32_bf16 v[60:63], v[252:255], v[92:95], v[60:63]
    ds_read_b64_tr_b16 v[76:77], v45 offset:53248
    v_mfma_f32_16x16x32_bf16 v[52:55], v[252:255], v[88:91], v[52:55]
    ds_read_b64_tr_b16 v[78:79], v45 offset:53760
    v_cvt_pk_bf16_f32 v36, v48, v49
    v_cvt_pk_bf16_f32 v37, v50, v51
    s_nop 4
    v_cvt_pk_bf16_f32 v38, v52, v53
    v_cvt_pk_bf16_f32 v39, v54, v55
    v_cvt_pk_bf16_f32 v40, v56, v57
    v_cvt_pk_bf16_f32 v41, v58, v59
    v_cvt_pk_bf16_f32 v42, v60, v61
    v_cvt_pk_bf16_f32 v43, v62, v63
    ds_write_b128 v33, v[36:39]
    ds_write_b128 v33, v[40:43] offset:256
    s_lshl_b32 s87, s68, 13
    s_add_u32 s87, s87, 73728
    v_add_u32 v33, s87, v1
    s_setprio 2
    s_waitcnt vmcnt(0) lgkmcnt(0)
    s_barrier
    ds_read_b64_tr_b16 v[112:113], v46 offset:0
    ds_read_b64_tr_b16 v[114:115], v46 offset:2176
    ds_read_b128 v[120:123], v33 offset:0
    ds_read_b64_tr_b16 v[116:117], v46 offset:1088
    ds_read_b64_tr_b16 v[118:119], v46 offset:3264
    ds_read_b128 v[124:127], v33 offset:1024
    ds_read_b64_tr_b16 v[128:129], v46 offset:4352
    ds_read_b64_tr_b16 v[130:131], v46 offset:6528
    ds_read_b128 v[136:139], v33 offset:2048
    ds_read_b64_tr_b16 v[132:133], v46 offset:5440
    ds_read_b64_tr_b16 v[134:135], v46 offset:7616
    ds_read_b128 v[140:143], v33 offset:3072
    s_waitcnt lgkmcnt(9)
    v_mfma_f32_32x32x16_bf16 v[48:63], v[112:115], v[120:123], 0
    s_waitcnt lgkmcnt(6)
    v_mfma_f32_32x32x16_bf16 v[48:63], v[116:119], v[124:127], v[48:63]
    ds_read_b64_tr_b16 v[112:113], v46 offset:8704
    ds_read_b64_tr_b16 v[114:115], v46 offset:10880
    ds_read_b128 v[120:123], v33 offset:4096
    ds_read_b64_tr_b16 v[116:117], v46 offset:9792
    ds_read_b64_tr_b16 v[118:119], v46 offset:11968
    ds_read_b128 v[124:127], v33 offset:5120
    s_waitcnt lgkmcnt(9)
    v_mfma_f32_32x32x16_bf16 v[48:63], v[128:131], v[136:139], v[48:63]
    s_waitcnt lgkmcnt(6)
    v_mfma_f32_32x32x16_bf16 v[48:63], v[132:135], v[140:143], v[48:63]
    ds_read_b64_tr_b16 v[128:129], v46 offset:13056
    ds_read_b64_tr_b16 v[130:131], v46 offset:15232
    ds_read_b128 v[136:139], v33 offset:6144
    ds_read_b64_tr_b16 v[132:133], v46 offset:14144
    ds_read_b64_tr_b16 v[134:135], v46 offset:16320
    ds_read_b128 v[140:143], v33 offset:7168
    s_waitcnt lgkmcnt(9)
    v_mfma_f32_32x32x16_bf16 v[48:63], v[112:115], v[120:123], v[48:63]
    s_waitcnt lgkmcnt(6)
    v_mfma_f32_32x32x16_bf16 v[48:63], v[116:119], v[124:127], v[48:63]
    s_waitcnt lgkmcnt(3)
    v_mfma_f32_32x32x16_bf16 v[48:63], v[128:131], v[136:139], v[48:63]
    s_waitcnt lgkmcnt(0)
    v_mfma_f32_32x32x16_bf16 v[48:63], v[132:135], v[140:143], v[48:63]
    s_atomic_add s26, s[36:37], s0
    s_lshl_b32 s99, s65, 11
    s_add_u32 s99, s99, s15
    s_nop 8
    v_cvt_pk_bf16_f32 v36, v48, v49
    v_cvt_pk_bf16_f32 v37, v50, v51
    v_cvt_pk_bf16_f32 v38, v52, v53
    v_cvt_pk_bf16_f32 v39, v54, 0
    v_or_b32 v39, s58, v39
    buffer_store_dwordx4 v[36:39], v1, s[36:39], s99 offen offset:0 sc1
    v_cvt_pk_bf16_f32 v40, v56, v57
    v_cvt_pk_bf16_f32 v41, v58, v59
    v_cvt_pk_bf16_f32 v42, v60, v61
    v_cvt_pk_bf16_f32 v43, v62, 0
    v_or_b32 v43, s58, v43
    buffer_store_dwordx4 v[40:43], v1, s[36:39], s99 offen offset:1024 sc1
    s_setprio 0
    s_and_b32 s87, s71, 0x1fff
    s_mul_i32 s80, s73, 448
    s_lshl_b32 s73, s73, 6
    s_add_u32 s73, s73, s87
    s_mul_i32 s81, s74, 448
    s_lshl_b32 s74, s74, 6
    s_add_u32 s74, s74, s87
    s_mul_i32 s82, s75, 448
    s_lshl_b32 s75, s75, 6
    s_add_u32 s75, s75, s87
    s_mul_i32 s83, s76, 448
    s_lshl_b32 s76, s76, 6
    s_add_u32 s76, s76, s87
    s_mul_i32 s84, s77, 448
    s_lshl_b32 s77, s77, 6
    s_add_u32 s77, s77, s87
    s_mul_i32 s85, s78, 448
    s_lshl_b32 s78, s78, 6
    s_add_u32 s78, s78, s87
    s_mul_i32 s86, s79, 448
    s_lshl_b32 s79, s79, 6
    s_add_u32 s79, s79, s87
    s_barrier
    s_add_u32 m0, s73, 49152
    s_nop 0
    buffer_load_dwordx4 v2, s[40:43], s80 offen lds
    buffer_load_dwordx4 v3, s[40:43], s80 offen offset:1024 lds
    v_mfma_f32_16x16x32_bf16 v[96:99], v[64:67], v[144:147], 0
    ds_read_b64_tr_b16 v[80:81], v44 offset:40960
    s_add_u32 m0, s74, 49152
    s_nop 0
    buffer_load_dwordx4 v2, s[40:43], s81 offen lds
    v_mfma_f32_16x16x32_bf16 v[104:107], v[68:71], v[144:147], 0
    ds_read_b64_tr_b16 v[82:83], v44 offset:41472
    v_mfma_f32_16x16x32_bf16 v[108:111], v[68:71], v[148:151], 0
    ds_read_b64_tr_b16 v[84:85], v45 offset:40960
    v_mfma_f32_16x16x32_bf16 v[100:103], v[64:67], v[148:151], 0
    ds_read_b64_tr_b16 v[86:87], v45 offset:41472
    v_mfma_f32_16x16x32_bf16 v[96:99], v[72:75], v[152:155], v[96:99]
    ds_read_b64_tr_b16 v[88:89], v44 offset:45056
    v_mfma_f32_16x16x32_bf16 v[104:107], v[76:79], v[152:155], v[104:107]
    ds_read_b64_tr_b16 v[90:91], v44 offset:45568
    v_mfma_f32_16x16x32_bf16 v[108:111], v[76:79], v[156:159], v[108:111]
    ds_read_b64_tr_b16 v[92:93], v45 offset:45056
    buffer_load_dwordx4 v3, s[40:43], s81 offen offset:1024 lds
    v_mfma_f32_16x16x32_bf16 v[100:103], v[72:75], v[156:159], v[100:103]
    ds_read_b64_tr_b16 v[94:95], v45 offset:45568
    s_waitcnt lgkmcnt(0)
    v_mfma_f32_16x16x32_bf16 v[96:99], v[80:83], v[160:163], v[96:99]
    ds_read_b64_tr_b16 v[64:65], v44 offset:32768
    s_add_u32 m0, s75, 49152
    s_nop 0
    buffer_load_dwordx4 v2, s[40:43], s82 offen lds
    v_mfma_f32_16x16x32_bf16 v[104:107], v[84:87], v[160:163], v[104:107]
    ds_read_b64_tr_b16 v[66:67], v44 offset:33280
    v_mfma_f32_16x16x32_bf16 v[108:111], v[84:87], v[164:167], v[108:111]
    ds_read_b64_tr_b16 v[68:69], v45 offset:32768
    v_mfma_f32_16x16x32_bf16 v[100:103], v[80:83], v[164:167], v[100:103]
    ds_read_b64_tr_b16 v[70:71], v45 offset:33280
    v_mfma_f32_16x16x32_bf16 v[96:99], v[88:91], v[168:171], v[96:99]
    ds_read_b64_tr_b16 v[72:73], v44 offset:36864
    v_mfma_f32_16x16x32_bf16 v[104:107], v[92:95], v[168:171], v[104:107]
    ds_read_b64_tr_b16 v[74:75], v44 offset:37376
    v_mfma_f32_16x16x32_bf16 v[108:111], v[92:95], v[172:175], v[108:111]
    ds_read_b64_tr_b16 v[76:77], v45 offset:36864
    buffer_load_dwordx4 v3, s[40:43], s82 offen offset:1024 lds
    v_mfma_f32_16x16x32_bf16 v[100:103], v[88:91], v[172:175], v[100:103]
    ds_read_b64_tr_b16 v[78:79], v45 offset:37376
    s_waitcnt lgkmcnt(6)
    v_mfma_f32_16x16x32_bf16 v[96:99], v[64:67], v[176:179], v[96:99]
    ds_read_b64_tr_b16 v[80:81], v44 offset:24576
    s_add_u32 m0, s76, 49152
    s_nop 0
    buffer_load_dwordx4 v2, s[40:43], s83 offen lds
    s_waitcnt lgkmcnt(5)
    v_mfma_f32_16x16x32_bf16 v[104:107], v[68:71], v[176:179], v[104:107]
    ds_read_b64_tr_b16 v[82:83], v44 offset:25088
    v_mfma_f32_16x16x32_bf16 v[108:111], v[68:71], v[180:183], v[108:111]
    ds_read_b64_tr_b16 v[84:85], v45 offset:24576
    v_mfma_f32_16x16x32_bf16 v[100:103], v[64:67], v[180:183], v[100:103]
    ds_read_b64_tr_b16 v[86:87], v45 offset:25088
    s_waitcnt lgkmcnt(6)
    v_mfma_f32_16x16x32_bf16 v[96:99], v[72:75], v[184:187], v[96:99]
    ds_read_b64_tr_b16 v[88:89], v44 offset:28672
    s_waitcnt lgkmcnt(5)
    v_mfma_f32_16x16x32_bf16 v[104:107], v[76:79], v[184:187], v[104:107]
    ds_read_b64_tr_b16 v[90:91], v44 offset:29184
    v_mfma_f32_16x16x32_bf16 v[108:111], v[76:79], v[188:191], v[108:111]
    ds_read_b64_tr_b16 v[92:93], v45 offset:28672
    buffer_load_dwordx4 v3, s[40:43], s83 offen offset:1024 lds
    v_mfma_f32_16x16x32_bf16 v[100:103], v[72:75], v[188:191], v[100:103]
    ds_read_b64_tr_b16 v[94:95], v45 offset:29184
    s_waitcnt lgkmcnt(6)
    v_mfma_f32_16x16x32_bf16 v[96:99], v[80:83], v[192:195], v[96:99]
    ds_read_b64_tr_b16 v[64:65], v44 offset:16384
    s_add_u32 m0, s77, 49152
    s_nop 0
    buffer_load_dwordx4 v2, s[40:43], s84 offen lds
    s_waitcnt lgkmcnt(5)
    v_mfma_f32_16x16x32_bf16 v[104:107], v[84:87], v[192:195], v[104:107]
    ds_read_b64_tr_b16 v[66:67], v44 offset:16896
    v_mfma_f32_16x16x32_bf16 v[108:111], v[84:87], v[196:199], v[108:111]
    ds_read_b64_tr_b16 v[68:69], v45 offset:16384
    v_mfma_f32_16x16x32_bf16 v[100:103], v[80:83], v[196:199], v[100:103]
    ds_read_b64_tr_b16 v[70:71], v45 offset:16896
    s_waitcnt lgkmcnt(6)
    v_mfma_f32_16x16x32_bf16 v[96:99], v[88:91], v[200:203], v[96:99]
    ds_read_b64_tr_b16 v[72:73], v44 offset:20480
    s_waitcnt lgkmcnt(5)
    v_mfma_f32_16x16x32_bf16 v[104:107], v[92:95], v[200:203], v[104:107]
    ds_read_b64_tr_b16 v[74:75], v44 offset:20992
    v_mfma_f32_16x16x32_bf16 v[108:111], v[92:95], v[204:207], v[108:111]
    ds_read_b64_tr_b16 v[76:77], v45 offset:20480
    buffer_load_dwordx4 v3, s[40:43], s84 offen offset:1024 lds
    v_mfma_f32_16x16x32_bf16 v[100:103], v[88:91], v[204:207], v[100:103]
    ds_read_b64_tr_b16 v[78:79], v45 offset:20992
    s_waitcnt lgkmcnt(6)
    v_mfma_f32_16x16x32_bf16 v[96:99], v[64:67], v[208:211], v[96:99]
    ds_read_b64_tr_b16 v[80:81], v44 offset:8192
    s_add_u32 m0, s78, 49152
    s_nop 0
    buffer_load_dwordx4 v2, s[40:43], s85 offen lds
    s_waitcnt lgkmcnt(5)
    v_mfma_f32_16x16x32_bf16 v[104:107], v[68:71], v[208:211], v[104:107]
    ds_read_b64_tr_b16 v[82:83], v44 offset:8704
    v_mfma_f32_16x16x32_bf16 v[108:111], v[68:71], v[212:215], v[108:111]
    ds_read_b64_tr_b16 v[84:85], v45 offset:8192
    v_mfma_f32_16x16x32_bf16 v[100:103], v[64:67], v[212:215], v[100:103]
    ds_read_b64_tr_b16 v[86:87], v45 offset:8704
    s_waitcnt lgkmcnt(6)
    v_mfma_f32_16x16x32_bf16 v[96:99], v[72:75], v[216:219], v[96:99]
    ds_read_b64_tr_b16 v[88:89], v44 offset:12288
    s_waitcnt lgkmcnt(5)
    v_mfma_f32_16x16x32_bf16 v[104:107], v[76:79], v[216:219], v[104:107]
    ds_read_b64_tr_b16 v[90:91], v44 offset:12800
    v_mfma_f32_16x16x32_bf16 v[108:111], v[76:79], v[220:223], v[108:111]
    ds_read_b64_tr_b16 v[92:93], v45 offset:12288
    buffer_load_dwordx4 v3, s[40:43], s85 offen offset:1024 lds
    v_mfma_f32_16x16x32_bf16 v[100:103], v[72:75], v[220:223], v[100:103]
    ds_read_b64_tr_b16 v[94:95], v45 offset:12800
    s_waitcnt lgkmcnt(6)
    v_mfma_f32_16x16x32_bf16 v[96:99], v[80:83], v[224:227], v[96:99]
    ds_read_b64_tr_b16 v[64:65], v44 offset:0
    s_add_u32 m0, s79, 49152
    s_nop 0
    buffer_load_dwordx4 v2, s[40:43], s86 offen lds
    s_waitcnt lgkmcnt(5)
    v_mfma_f32_16x16x32_bf16 v[104:107], v[84:87], v[224:227], v[104:107]
    ds_read_b64_tr_b16 v[66:67], v44 offset:512
    v_mfma_f32_16x16x32_bf16 v[108:111], v[84:87], v[228:231], v[108:111]
    ds_read_b64_tr_b16 v[68:69], v45 offset:0
    v_mfma_f32_16x16x32_bf16 v[100:103], v[80:83], v[228:231], v[100:103]
    ds_read_b64_tr_b16 v[70:71], v45 offset:512
    s_waitcnt lgkmcnt(6)
    v_mfma_f32_16x16x32_bf16 v[96:99], v[88:91], v[232:235], v[96:99]
    ds_read_b64_tr_b16 v[72:73], v44 offset:4096
    s_waitcnt lgkmcnt(5)
    v_mfma_f32_16x16x32_bf16 v[104:107], v[92:95], v[232:235], v[104:107]
    ds_read_b64_tr_b16 v[74:75], v44 offset:4608
    v_mfma_f32_16x16x32_bf16 v[108:111], v[92:95], v[236:239], v[108:111]
    ds_read_b64_tr_b16 v[76:77], v45 offset:4096
    buffer_load_dwordx4 v3, s[40:43], s86 offen offset:1024 lds
    v_mfma_f32_16x16x32_bf16 v[100:103], v[88:91], v[236:239], v[100:103]
    ds_read_b64_tr_b16 v[78:79], v45 offset:4608
    s_waitcnt lgkmcnt(6)
    v_mfma_f32_16x16x32_bf16 v[96:99], v[64:67], v[240:243], v[96:99]
    s_add_u32 m0, s73, 106496
    s_nop 0
    buffer_load_dwordx4 v2, s[44:47], s80 offen lds
    s_waitcnt lgkmcnt(4)
    v_mfma_f32_16x16x32_bf16 v[104:107], v[68:71], v[240:243], v[104:107]
    v_mfma_f32_16x16x32_bf16 v[108:111], v[68:71], v[244:247], v[108:111]
    v_mfma_f32_16x16x32_bf16 v[100:103], v[64:67], v[244:247], v[100:103]
    s_waitcnt lgkmcnt(2)
    v_mfma_f32_16x16x32_bf16 v[96:99], v[72:75], v[248:251], v[96:99]
    s_waitcnt lgkmcnt(0)
    v_mfma_f32_16x16x32_bf16 v[104:107], v[76:79], v[248:251], v[104:107]
    v_mfma_f32_16x16x32_bf16 v[108:111], v[76:79], v[252:255], v[108:111]
    buffer_load_dwordx4 v3, s[44:47], s80 offen offset:1024 lds
    v_mfma_f32_16x16x32_bf16 v[100:103], v[72:75], v[252:255], v[100:103]
    s_nop 2
    v_cvt_pk_bf16_f32 v36, v96, v97
    v_cvt_pk_bf16_f32 v37, v98, v99
    s_nop 2
    v_cvt_pk_bf16_f32 v38, v100, v101
    v_cvt_pk_bf16_f32 v39, v102, v103
    v_cvt_pk_bf16_f32 v40, v104, v105
    v_cvt_pk_bf16_f32 v41, v106, v107
    v_cvt_pk_bf16_f32 v42, v108, v109
    v_cvt_pk_bf16_f32 v43, v110, v111
    v_permlane16_swap_b32 v36, v38
    v_permlane16_swap_b32 v37, v39
    v_permlane16_swap_b32 v40, v42
    v_permlane16_swap_b32 v41, v43
    v_cndmask_b32 v42, v42, 0, s[90:91]
    v_mfma_f32_32x32x16_bf16 v[112:127], v[24:27], v[36:39], 0
    s_nop 0
    v_mfma_f32_32x32x16_bf16 v[112:127], v[28:31], v[40:43], v[112:127]
    v_mul_f32 v4, 0xbfb8aa3b, v108
    v_mul_f32 v12, 0xbfb8aa3b, v104
    s_nop 1
    v_permlane16_swap_b32 v12, v4
    v_mov_b32 v12, v4
    s_nop 1
    v_permlane32_swap_b32 v12, v4
    v_exp_f32 v4, v4
    s_nop 0
    v_add_f32 v4, 1.0, v4
    v_rcp_f32 v4, v4
    v_exp_f32_e64 v128, -v112
    s_add_u32 m0, s74, 106496
    s_nop 0
    buffer_load_dwordx4 v2, s[44:47], s81 offen lds
    v_exp_f32 v112, v112
    v_exp_f32_e64 v129, -v113
    v_exp_f32 v113, v113
    v_exp_f32_e64 v130, -v114
    v_exp_f32 v114, v114
    v_exp_f32_e64 v131, -v115
    v_exp_f32 v115, v115
    buffer_load_dwordx4 v3, s[44:47], s81 offen offset:1024 lds
    v_exp_f32_e64 v132, -v116
    v_exp_f32 v116, v116
    s_add_u32 m0, s75, 106496
    s_nop 0
    buffer_load_dwordx4 v2, s[44:47], s82 offen lds
    v_exp_f32_e64 v133, -v117
    v_exp_f32 v117, v117
    v_exp_f32_e64 v134, -v118
    v_exp_f32 v118, v118
    v_exp_f32_e64 v135, -v126
    v_exp_f32 v119, v126
    v_exp_f32_e64 v136, -v120
    buffer_load_dwordx4 v3, s[44:47], s82 offen offset:1024 lds
    v_exp_f32 v120, v120
    v_exp_f32_e64 v137, -v121
    s_add_u32 m0, s76, 106496
    s_nop 0
    buffer_load_dwordx4 v2, s[44:47], s83 offen lds
    v_exp_f32 v121, v121
    v_exp_f32_e64 v138, -v122
    v_exp_f32 v122, v122
    v_exp_f32_e64 v139, -v123
    v_exp_f32 v123, v123
    v_exp_f32_e64 v140, -v124
    v_exp_f32 v124, v124
    buffer_load_dwordx4 v3, s[44:47], s83 offen offset:1024 lds
    v_exp_f32_e64 v141, -v125
    v_exp_f32 v125, v125
    v_pk_add_f32 v[18:19], v[112:113], v[114:115]
    s_add_u32 m0, s77, 106496
    s_nop 0
    buffer_load_dwordx4 v2, s[44:47], s84 offen lds
    v_pk_add_f32 v[20:21], v[128:129], v[130:131]
    v_pk_add_f32 v[18:19], v[18:19], v[116:117]
    v_pk_add_f32 v[20:21], v[20:21], v[132:133]
    v_pk_add_f32 v[18:19], v[18:19], v[118:119]
    v_pk_add_f32 v[20:21], v[20:21], v[134:135]
    v_pk_add_f32 v[18:19], v[18:19], v[120:121]
    v_pk_add_f32 v[20:21], v[20:21], v[136:137]
    v_pk_add_f32 v[18:19], v[18:19], v[122:123]
    v_pk_add_f32 v[20:21], v[20:21], v[138:139]
    v_pk_add_f32 v[18:19], v[18:19], v[124:125]
    v_pk_add_f32 v[20:21], v[20:21], v[140:141]
    v_add_f32 v12, v18, v19
    v_add_f32 v13, v20, v21
    s_nop 1
    v_permlane32_swap_b32 v12, v13
    buffer_load_dwordx4 v3, s[44:47], s84 offen offset:1024 lds
    v_add_f32 v12, v12, v13
    v_subrev_u32 v13, 0xf800000, v12
    v_cmp_le_u32 vcc, 0x6c000000, v13
    s_mov_b32 s98, 1
    s_cbranch_vccnz L_phixq
L_phir_q0:
    s_add_u32 m0, s78, 106496
    s_nop 0
    buffer_load_dwordx4 v2, s[44:47], s85 offen lds
    v_rcp_f32 v14, v12
    s_nop 0
    v_mov_b32 v16, v14
    s_nop 1
    v_permlane32_swap_b32 v14, v16
    v_pk_mul_f32 v[112:113], v[112:113], v[14:15] op_sel_hi:[1,0]
    v_cvt_pk_bf16_f32 v64, v112, v113
    v_pk_mul_f32 v[128:129], v[128:129], v[16:17] op_sel_hi:[1,0]
    v_cvt_pk_bf16_f32 v72, v128, v129
    v_pk_mul_f32 v[114:115], v[114:115], v[14:15] op_sel_hi:[1,0]
    v_cvt_pk_bf16_f32 v65, v114, v115
    v_pk_mul_f32 v[130:131], v[130:131], v[16:17] op_sel_hi:[1,0]
    buffer_load_dwordx4 v3, s[44:47], s85 offen offset:1024 lds
    v_cvt_pk_bf16_f32 v73, v130, v131
    v_pk_mul_f32 v[116:117], v[116:117], v[14:15] op_sel_hi:[1,0]
    v_cvt_pk_bf16_f32 v66, v116, v117
    v_pk_mul_f32 v[132:133], v[132:133], v[16:17] op_sel_hi:[1,0]
    v_cvt_pk_bf16_f32 v74, v132, v133
    s_add_u32 m0, s79, 106496
    s_nop 0
    buffer_load_dwordx4 v2, s[44:47], s86 offen lds
    v_pk_mul_f32 v[118:119], v[118:119], v[14:15] op_sel_hi:[1,0]
    v_cvt_pk_bf16_f32 v67, v118, 0
    v_pk_mul_f32 v[134:135], v[134:135], v[16:17] op_sel_hi:[1,0]
    v_cvt_pk_bf16_f32 v75, v134, 0
    v_pk_mul_f32 v[120:121], v[120:121], v[14:15] op_sel_hi:[1,0]
    v_cvt_pk_bf16_f32 v68, v120, v121
    v_pk_mul_f32 v[136:137], v[136:137], v[16:17] op_sel_hi:[1,0]
    v_cvt_pk_bf16_f32 v76, v136, v137
    v_pk_mul_f32 v[122:123], v[122:123], v[14:15] op_sel_hi:[1,0]
    v_cvt_pk_bf16_f32 v69, v122, v123
    v_pk_mul_f32 v[138:139], v[138:139], v[16:17] op_sel_hi:[1,0]
    v_cvt_pk_bf16_f32 v77, v138, v139
    v_pk_mul_f32 v[124:125], v[124:125], v[14:15] op_sel_hi:[1,0]
    v_cvt_pk_bf16_f32 v70, v124, v125
    buffer_load_dwordx4 v3, s[44:47], s86 offen offset:1024 lds
    v_pk_mul_f32 v[140:141], v[140:141], v[16:17] op_sel_hi:[1,0]
    v_cvt_pk_bf16_f32 v78, v140, v141
    v_cvt_pk_bf16_f32 v71, v119, 0
    v_cvt_pk_bf16_f32 v79, v135, 0
    s_barrier
    s_load_dwordx4 s[28:31], s[56:57], s64 glc
    s_load_dwordx4 s[32:35], s[56:57], s70 glc
L_rk0:
    buffer_load_dwordx4 v[80:83], v11, s[36:39], s18 offen offset:0 sc1
    buffer_load_dwordx4 v[84:87], v11, s[36:39], s18 offen offset:1024 sc1
    buffer_load_dwordx4 v[88:91], v11, s[36:39], s18 offen offset:2048 sc1
    buffer_load_dwordx4 v[92:95], v11, s[36:39], s18 offen offset:3072 sc1
    s_waitcnt vmcnt(3)
    v_xor_b32 v83, s58, v83
    v_mov_b32 v14, v83
    s_nop 0
    v_mfma_f32_32x32x16_bf16 v[112:127], v[80:83], v[64:67], 0
    s_waitcnt vmcnt(2)
    v_xor_b32 v87, s58, v87
    v_or_b32 v14, v14, v87
    s_nop 0
    v_mfma_f32_32x32x16_bf16 v[112:127], v[84:87], v[68:71], v[112:127]
    s_waitcnt vmcnt(1)
    v_xor_b32 v91, s58, v91
    v_or_b32 v14, v14, v91
    s_nop 0
    v_mfma_f32_32x32x16_bf16 v[112:127], v[88:91], v[72:75], v[112:127]
    s_waitcnt vmcnt(0)
    v_xor_b32 v95, s58, v95
    v_or_b32 v14, v14, v95
    s_nop 0
    v_mfma_f32_32x32x16_bf16 v[112:127], v[92:95], v[76:79], v[112:127]
    v_cmp_lt_u32 vcc, 0xffff, v14
    s_add_u32 s59, s59, 1
    s_cmp_gt_u32 s59, 100000
    s_cbranch_scc1 L_rk0_ok
    s_cbranch_vccnz L_rk0
L_rk0_ok:
    s_nop 6
    s_nop 0
    v_add_f32 v119, 0x358637bd, v119
    v_rcp_f32 v12, v119
    s_nop 0
    v_mul_f32 v12, v12, v4
    v_mul_f32 v112, v112, v12
    v_mul_f32 v113, v113, v12
    v_cvt_pk_bf16_f32 v128, v112, v113
    v_mul_f32 v114, v114, v12
    v_mul_f32 v115, v115, v12
    v_cvt_pk_bf16_f32 v129, v114, v115
    v_mul_f32 v116, v116, v12
    v_mul_f32 v117, v117, v12
    v_cvt_pk_bf16_f32 v130, v116, v117
    v_mul_f32 v118, v118, v12
    v_cvt_pk_bf16_f32 v131, v118, 0
    v_or_b32 v131, s58, v131
    buffer_store_dwordx4 v[128:131], v5, s[36:39], 0 offen offset:0 sc1
    v_mul_f32 v120, v120, v12
    v_mul_f32 v121, v121, v12
    v_cvt_pk_bf16_f32 v132, v120, v121
    v_mul_f32 v122, v122, v12
    v_mul_f32 v123, v123, v12
    v_cvt_pk_bf16_f32 v133, v122, v123
    v_mul_f32 v124, v124, v12
    v_mul_f32 v125, v125, v12
    v_cvt_pk_bf16_f32 v134, v124, v125
    v_mul_f32 v126, v126, v12
    v_cvt_pk_bf16_f32 v135, v126, 0
    v_or_b32 v135, s58, v135
    buffer_store_dwordx4 v[132:135], v5, s[36:39], 0 offen offset:1024 sc1
    v_mov_b32 v20, s1
    v_mov_b32 v21, s26
    s_mov_b64 exec, 1
    buffer_store_dword v21, v20, s[36:39], 0 offen sc1
    s_mov_b64 exec, -1
    s_barrier
    s_cmp_eq_u32 s21, 0
    s_cbranch_scc1 L_tailb
    s_mov_b32 s74, 0
    s_mov_b32 s93, 0
    s_waitcnt lgkmcnt(0)
    s_branch L_p3_chk
L_A1:
    s_setprio 0
    s_add_u32 m0, s72, 63744
    s_nop 0
    buffer_load_dwordx4 v34, s[32:35], s81 offen offset:1792 lds
    s_add_u32 m0, s72, 71936
    s_nop 0
    buffer_load_dwordx4 v34, s[32:35], s82 offen offset:1792 lds
    s_nop 2
    v_exp_f32_e64 v128, -v112
    v_exp_f32 v112, v112
    v_exp_f32_e64 v129, -v113
    v_exp_f32 v113, v113
    v_exp_f32_e64 v130, -v114
    v_exp_f32 v114, v114
    v_exp_f32_e64 v131, -v115
    v_exp_f32 v115, v115
    v_exp_f32_e64 v132, -v116
    v_exp_f32 v116, v116
    v_exp_f32_e64 v133, -v117
    v_exp_f32 v117, v117
    v_exp_f32_e64 v134, -v118
    v_exp_f32 v118, v118
    v_exp_f32_e64 v135, -v126
    v_exp_f32 v119, v126
    v_exp_f32_e64 v136, -v120
    v_exp_f32 v120, v120
    v_exp_f32_e64 v137, -v121
    v_exp_f32 v121, v121
    v_exp_f32_e64 v138, -v122
    v_exp_f32 v122, v122
    v_exp_f32_e64 v139, -v123
    v_exp_f32 v123, v123
    v_exp_f32_e64 v140, -v124
    v_exp_f32 v124, v124
    v_exp_f32_e64 v141, -v125
    v_exp_f32 v125, v125
    v_pk_add_f32 v[18:19], v[112:113], v[114:115]
    v_pk_add_f32 v[20:21], v[128:129], v[130:131]
    v_pk_add_f32 v[18:19], v[18:19], v[116:117]
    v_pk_add_f32 v[20:21], v[20:21], v[132:133]
    v_pk_add_f32 v[18:19], v[18:19], v[118:119]
    v_pk_add_f32 v[20:21], v[20:21], v[134:135]
    v_pk_add_f32 v[18:19], v[18:19], v[120:121]
    v_pk_add_f32 v[20:21], v[20:21], v[136:137]
    v_pk_add_f32 v[18:19], v[18:19], v[122:123]
    v_pk_add_f32 v[20:21], v[20:21], v[138:139]
    v_pk_add_f32 v[18:19], v[18:19], v[124:125]
    v_pk_add_f32 v[20:21], v[20:21], v[140:141]
    v_add_f32 v12, v18, v19
    v_add_f32 v13, v20, v21
    s_nop 1
    v_permlane32_swap_b32 v12, v13
    v_add_f32 v12, v12, v13
    v_subrev_u32 v13, 0xf800000, v12
    v_cmp_le_u32 vcc, 0x6c000000, v13
    s_mov_b32 s98, 2
    s_cbranch_vccnz L_phixk
L_phir_k1:
    v_rcp_f32 v14, v12
    s_nop 0
    v_mov_b32 v16, v14
    s_nop 1
    v_permlane32_swap_b32 v14, v16
    v_pk_mul_f32 v[112:113], v[112:113], v[14:15] op_sel_hi:[1,0]
    v_cvt_pk_bf16_f32 v96, v112, v113
    v_pk_mul_f32 v[128:129], v[128:129], v[16:17] op_sel_hi:[1,0]
    v_cvt_pk_bf16_f32 v104, v128, v129
    v_pk_mul_f32 v[114:115], v[114:115], v[14:15] op_sel_hi:[1,0]
    v_cvt_pk_bf16_f32 v97, v114, v115
    v_pk_mul_f32 v[130:131], v[130:131], v[16:17] op_sel_hi:[1,0]
    v_cvt_pk_bf16_f32 v105, v130, v131
    ds_write_b64 v32, v[96:97] offset:0
    ds_write_b64 v32, v[104:105] offset:64
    v_pk_mul_f32 v[116:117], v[116:117], v[14:15] op_sel_hi:[1,0]
    v_cvt_pk_bf16_f32 v98, v116, v117
    v_pk_mul_f32 v[132:133], v[132:133], v[16:17] op_sel_hi:[1,0]
    v_cvt_pk_bf16_f32 v106, v132, v133
    v_pk_mul_f32 v[118:119], v[118:119], v[14:15] op_sel_hi:[1,0]
    v_cvt_pk_bf16_f32 v99, v118, 0
    v_pk_mul_f32 v[134:135], v[134:135], v[16:17] op_sel_hi:[1,0]
    v_cvt_pk_bf16_f32 v107, v134, 0
    ds_write_b64 v32, v[98:99] offset:16
    ds_write_b64 v32, v[106:107] offset:80
    v_pk_mul_f32 v[120:121], v[120:121], v[14:15] op_sel_hi:[1,0]
    v_cvt_pk_bf16_f32 v100, v120, v121
    v_pk_mul_f32 v[136:137], v[136:137], v[16:17] op_sel_hi:[1,0]
    v_cvt_pk_bf16_f32 v108, v136, v137
    v_pk_mul_f32 v[122:123], v[122:123], v[14:15] op_sel_hi:[1,0]
    v_cvt_pk_bf16_f32 v101, v122, v123
    v_pk_mul_f32 v[138:139], v[138:139], v[16:17] op_sel_hi:[1,0]
    v_cvt_pk_bf16_f32 v109, v138, v139
    ds_write_b64 v32, v[100:101] offset:32
    ds_write_b64 v32, v[108:109] offset:96
    v_pk_mul_f32 v[124:125], v[124:125], v[14:15] op_sel_hi:[1,0]
    v_cvt_pk_bf16_f32 v102, v124, v125
    v_pk_mul_f32 v[140:141], v[140:141], v[16:17] op_sel_hi:[1,0]
    v_cvt_pk_bf16_f32 v110, v140, v141
    v_cvt_pk_bf16_f32 v103, v119, 0
    v_cvt_pk_bf16_f32 v111, v135, 0
    ds_write_b64 v32, v[102:103] offset:48
    ds_write_b64 v32, v[110:111] offset:112
    s_waitcnt vmcnt(0)
    s_barrier
    ds_read_b64_tr_b16 v[80:81], v40 offset:0
    s_add_u32 m0, s72, 96512
    s_nop 0
    buffer_load_dwordx4 v34, s[32:35], s85 offen offset:1792 lds
    ds_read_b64_tr_b16 v[82:83], v40 offset:512
    ds_read_b64_tr_b16 v[84:85], v41 offset:0
    ds_read_b64_tr_b16 v[86:87], v41 offset:512
    ds_read_b64_tr_b16 v[88:89], v40 offset:4096
    s_add_u32 m0, s72, 104704
    s_nop 0
    buffer_load_dwordx4 v34, s[32:35], s86 offen offset:1792 lds
    ds_read_b64_tr_b16 v[90:91], v40 offset:4608
    ds_read_b64_tr_b16 v[92:93], v41 offset:4096
    ds_read_b64_tr_b16 v[94:95], v41 offset:4608
    s_waitcnt lgkmcnt(6)
    v_mfma_f32_16x16x32_bf16 v[48:51], v[144:147], v[80:83], 0
    ds_read_b64_tr_b16 v[64:65], v40 offset:8192
    s_add_u32 m0, s72, 40960
    s_mov_b64 exec, s[8:9]
    buffer_load_dwordx4 v35, s[32:35], s81 offen offset:0 lds
    s_mov_b64 exec, -1
    s_waitcnt lgkmcnt(5)
    v_mfma_f32_16x16x32_bf16 v[56:59], v[144:147], v[84:87], v[56:59]
    ds_read_b64_tr_b16 v[66:67], v40 offset:8704
    v_mfma_f32_16x16x32_bf16 v[60:63], v[148:151], v[84:87], v[60:63]
    ds_read_b64_tr_b16 v[68:69], v41 offset:8192
    v_mfma_f32_16x16x32_bf16 v[52:55], v[148:151], v[80:83], 0
    ds_read_b64_tr_b16 v[70:71], v41 offset:8704
    s_waitcnt lgkmcnt(6)
    v_mfma_f32_16x16x32_bf16 v[48:51], v[152:155], v[88:91], v[48:51]
    ds_read_b64_tr_b16 v[72:73], v40 offset:12288
    s_waitcnt lgkmcnt(5)
    v_mfma_f32_16x16x32_bf16 v[56:59], v[152:155], v[92:95], v[56:59]
    ds_read_b64_tr_b16 v[74:75], v40 offset:12800
    v_mfma_f32_16x16x32_bf16 v[60:63], v[156:159], v[92:95], v[60:63]
    ds_read_b64_tr_b16 v[76:77], v41 offset:12288
    v_mfma_f32_16x16x32_bf16 v[52:55], v[156:159], v[88:91], v[52:55]
    ds_read_b64_tr_b16 v[78:79], v41 offset:12800
    s_waitcnt lgkmcnt(6)
    v_mfma_f32_16x16x32_bf16 v[48:51], v[160:163], v[64:67], v[48:51]
    ds_read_b64_tr_b16 v[80:81], v40 offset:16384
    s_add_u32 m0, s72, 32768
    s_mov_b64 exec, s[8:9]
    buffer_load_dwordx4 v35, s[32:35], s82 offen offset:0 lds
    s_mov_b64 exec, -1
    ds_read_b64_tr_b16 v[82:83], v40 offset:16896
    s_waitcnt lgkmcnt(6)
    v_mfma_f32_16x16x32_bf16 v[56:59], v[160:163], v[68:71], v[56:59]
    ds_read_b64_tr_b16 v[84:85], v41 offset:16384
    ds_read_b64_tr_b16 v[86:87], v41 offset:16896
    v_mfma_f32_16x16x32_bf16 v[60:63], v[164:167], v[68:71], v[60:63]
    ds_read_b64_tr_b16 v[88:89], v40 offset:20480
    v_mfma_f32_16x16x32_bf16 v[52:55], v[164:167], v[64:67], v[52:55]
    ds_read_b64_tr_b16 v[90:91], v40 offset:20992
    ds_read_b64_tr_b16 v[92:93], v41 offset:20480
    s_waitcnt lgkmcnt(9)
    v_mfma_f32_16x16x32_bf16 v[48:51], v[168:171], v[72:75], v[48:51]
    ds_read_b64_tr_b16 v[94:95], v41 offset:20992
    s_waitcnt lgkmcnt(8)
    v_mfma_f32_16x16x32_bf16 v[56:59], v[168:171], v[76:79], v[56:59]
    v_mfma_f32_16x16x32_bf16 v[60:63], v[172:175], v[76:79], v[60:63]
    v_mfma_f32_16x16x32_bf16 v[52:55], v[172:175], v[72:75], v[52:55]
    s_waitcnt lgkmcnt(0)
    s_barrier
    v_mfma_f32_16x16x32_bf16 v[48:51], v[176:179], v[80:83], v[48:51]
    ds_read_b64_tr_b16 v[64:65], v40 offset:24576
    s_add_u32 m0, s72, 24576
    s_mov_b64 exec, s[8:9]
    buffer_load_dwordx4 v35, s[32:35], s83 offen offset:0 lds
    s_mov_b64 exec, -1
    v_mfma_f32_16x16x32_bf16 v[56:59], v[176:179], v[84:87], v[56:59]
    ds_read_b64_tr_b16 v[66:67], v40 offset:25088
    v_mfma_f32_16x16x32_bf16 v[60:63], v[180:183], v[84:87], v[60:63]
    ds_read_b64_tr_b16 v[68:69], v41 offset:24576
    v_mfma_f32_16x16x32_bf16 v[52:55], v[180:183], v[80:83], v[52:55]
    ds_read_b64_tr_b16 v[70:71], v41 offset:25088
    v_mfma_f32_16x16x32_bf16 v[48:51], v[184:187], v[88:91], v[48:51]
    ds_read_b64_tr_b16 v[72:73], v40 offset:28672
    v_mfma_f32_16x16x32_bf16 v[56:59], v[184:187], v[92:95], v[56:59]
    ds_read_b64_tr_b16 v[74:75], v40 offset:29184
    v_mfma_f32_16x16x32_bf16 v[60:63], v[188:191], v[92:95], v[60:63]
    ds_read_b64_tr_b16 v[76:77], v41 offset:28672
    v_mfma_f32_16x16x32_bf16 v[52:55], v[188:191], v[88:91], v[52:55]
    ds_read_b64_tr_b16 v[78:79], v41 offset:29184
    s_waitcnt lgkmcnt(6)
    v_mfma_f32_16x16x32_bf16 v[48:51], v[192:195], v[64:67], v[48:51]
    ds_read_b64_tr_b16 v[80:81], v40 offset:32768
    s_add_u32 m0, s72, 16384
    s_mov_b64 exec, s[8:9]
    buffer_load_dwordx4 v35, s[32:35], s84 offen offset:0 lds
    s_mov_b64 exec, -1
    ds_read_b64_tr_b16 v[82:83], v40 offset:33280
    s_waitcnt lgkmcnt(6)
    v_mfma_f32_16x16x32_bf16 v[56:59], v[192:195], v[68:71], v[56:59]
    ds_read_b64_tr_b16 v[84:85], v41 offset:32768
    ds_read_b64_tr_b16 v[86:87], v41 offset:33280
    v_mfma_f32_16x16x32_bf16 v[60:63], v[196:199], v[68:71], v[60:63]
    ds_read_b64_tr_b16 v[88:89], v40 offset:36864
    v_mfma_f32_16x16x32_bf16 v[52:55], v[196:199], v[64:67], v[52:55]
    ds_read_b64_tr_b16 v[90:91], v40 offset:37376
    ds_read_b64_tr_b16 v[92:93], v41 offset:36864
    s_waitcnt lgkmcnt(9)
    v_mfma_f32_16x16x32_bf16 v[48:51], v[200:203], v[72:75], v[48:51]
    ds_read_b64_tr_b16 v[94:95], v41 offset:37376
    s_waitcnt lgkmcnt(8)
    v_mfma_f32_16x16x32_bf16 v[56:59], v[200:203], v[76:79], v[56:59]
    v_mfma_f32_16x16x32_bf16 v[60:63], v[204:207], v[76:79], v[60:63]
    v_mfma_f32_16x16x32_bf16 v[52:55], v[204:207], v[72:75], v[52:55]
    s_waitcnt vmcnt(4) lgkmcnt(0)
    s_barrier
    v_mfma_f32_16x16x32_bf16 v[48:51], v[208:211], v[80:83], v[48:51]
    ds_read_b64_tr_b16 v[64:65], v40 offset:40960
    s_add_u32 m0, s72, 8192
    s_mov_b64 exec, s[8:9]
    buffer_load_dwordx4 v35, s[32:35], s85 offen offset:0 lds
    s_mov_b64 exec, -1
    v_mfma_f32_16x16x32_bf16 v[56:59], v[208:211], v[84:87], v[56:59]
    ds_read_b64_tr_b16 v[66:67], v40 offset:41472
    v_mfma_f32_16x16x32_bf16 v[60:63], v[212:215], v[84:87], v[60:63]
    ds_read_b64_tr_b16 v[68:69], v41 offset:40960
    v_mfma_f32_16x16x32_bf16 v[52:55], v[212:215], v[80:83], v[52:55]
    ds_read_b64_tr_b16 v[70:71], v41 offset:41472
    v_mfma_f32_16x16x32_bf16 v[48:51], v[216:219], v[88:91], v[48:51]
    ds_read_b64_tr_b16 v[72:73], v40 offset:45056
    v_mfma_f32_16x16x32_bf16 v[56:59], v[216:219], v[92:95], v[56:59]
    ds_read_b64_tr_b16 v[74:75], v40 offset:45568
    v_mfma_f32_16x16x32_bf16 v[60:63], v[220:223], v[92:95], v[60:63]
    ds_read_b64_tr_b16 v[76:77], v41 offset:45056
    v_mfma_f32_16x16x32_bf16 v[52:55], v[220:223], v[88:91], v[52:55]
    ds_read_b64_tr_b16 v[78:79], v41 offset:45568
    s_waitcnt lgkmcnt(6)
    v_mfma_f32_16x16x32_bf16 v[48:51], v[224:227], v[64:67], v[48:51]
    ds_read_b64_tr_b16 v[80:81], v40 offset:49152
    s_add_u32 m0, s72, 0
    s_mov_b64 exec, s[8:9]
    buffer_load_dwordx4 v35, s[32:35], s86 offen offset:0 lds
    s_mov_b64 exec, -1
    s_waitcnt lgkmcnt(5)
    v_mfma_f32_16x16x32_bf16 v[56:59], v[224:227], v[68:71], v[56:59]
    ds_read_b64_tr_b16 v[82:83], v40 offset:49664
    v_mfma_f32_16x16x32_bf16 v[60:63], v[228:231], v[68:71], v[60:63]
    ds_read_b64_tr_b16 v[84:85], v41 offset:49152
    v_mfma_f32_16x16x32_bf16 v[52:55], v[228:231], v[64:67], v[52:55]
    ds_read_b64_tr_b16 v[86:87], v41 offset:49664
    s_waitcnt lgkmcnt(6)
    v_mfma_f32_16x16x32_bf16 v[48:51], v[232:235], v[72:75], v[48:51]
    ds_read_b64_tr_b16 v[88:89], v40 offset:53248
    s_waitcnt lgkmcnt(5)
    v_mfma_f32_16x16x32_bf16 v[56:59], v[232:235], v[76:79], v[56:59]
    ds_read_b64_tr_b16 v[90:91], v40 offset:53760
    v_mfma_f32_16x16x32_bf16 v[60:63], v[236:239], v[76:79], v[60:63]
    ds_read_b64_tr_b16 v[92:93], v41 offset:53248
    v_mfma_f32_16x16x32_bf16 v[52:55], v[236:239], v[72:75], v[52:55]
    ds_read_b64_tr_b16 v[94:95], v41 offset:53760
    s_waitcnt lgkmcnt(6)
    v_mfma_f32_16x16x32_bf16 v[48:51], v[240:243], v[80:83], v[48:51]
    ds_read_b64_tr_b16 v[64:65], v44 offset:49152
    s_waitcnt lgkmcnt(5)
    v_mfma_f32_16x16x32_bf16 v[56:59], v[240:243], v[84:87], v[56:59]
    ds_read_b64_tr_b16 v[66:67], v44 offset:49664
    v_mfma_f32_16x16x32_bf16 v[60:63], v[244:247], v[84:87], v[60:63]
    ds_read_b64_tr_b16 v[68:69], v45 offset:49152
    v_mfma_f32_16x16x32_bf16 v[52:55], v[244:247], v[80:83], v[52:55]
    ds_read_b64_tr_b16 v[70:71], v45 offset:49664
    s_waitcnt lgkmcnt(6)
    v_mfma_f32_16x16x32_bf16 v[48:51], v[248:251], v[88:91], v[48:51]
    ds_read_b64_tr_b16 v[72:73], v44 offset:53248
    s_waitcnt lgkmcnt(5)
    v_mfma_f32_16x16x32_bf16 v[56:59], v[248:251], v[92:95], v[56:59]
    ds_read_b64_tr_b16 v[74:75], v44 offset:53760
    v_mfma_f32_16x16x32_bf16 v[60:63], v[252:255], v[92:95], v[60:63]
    ds_read_b64_tr_b16 v[76:77], v45 offset:53248
    v_mfma_f32_16x16x32_bf16 v[52:55], v[252:255], v[88:91], v[52:55]
    ds_read_b64_tr_b16 v[78:79], v45 offset:53760
    v_cvt_pk_bf16_f32 v36, v48, v49
    v_cvt_pk_bf16_f32 v37, v50, v51
    s_nop 4
    v_cvt_pk_bf16_f32 v38, v52, v53
    v_cvt_pk_bf16_f32 v39, v54, v55
    v_cvt_pk_bf16_f32 v40, v56, v57
    v_cvt_pk_bf16_f32 v41, v58, v59
    v_cvt_pk_bf16_f32 v42, v60, v61
    v_cvt_pk_bf16_f32 v43, v62, v63
    ds_write_b128 v33, v[36:39]
    ds_write_b128 v33, v[40:43] offset:256
    s_setprio 1
    s_waitcnt vmcnt(0) lgkmcnt(0)
    s_barrier
    v_mfma_f32_16x16x32_bf16 v[96:99], v[64:67], v[144:147], 0
    ds_read_b64_tr_b16 v[80:81], v44 offset:40960
    v_mfma_f32_16x16x32_bf16 v[104:107], v[68:71], v[144:147], 0
    ds_read_b64_tr_b16 v[82:83], v44 offset:41472
    v_mfma_f32_16x16x32_bf16 v[108:111], v[68:71], v[148:151], 0
    ds_read_b64_tr_b16 v[84:85], v45 offset:40960
    v_mfma_f32_16x16x32_bf16 v[100:103], v[64:67], v[148:151], 0
    ds_read_b64_tr_b16 v[86:87], v45 offset:41472
    v_mfma_f32_16x16x32_bf16 v[96:99], v[72:75], v[152:155], v[96:99]
    ds_read_b64_tr_b16 v[88:89], v44 offset:45056
    v_mfma_f32_16x16x32_bf16 v[104:107], v[76:79], v[152:155], v[104:107]
    ds_read_b64_tr_b16 v[90:91], v44 offset:45568
    v_mfma_f32_16x16x32_bf16 v[108:111], v[76:79], v[156:159], v[108:111]
    ds_read_b64_tr_b16 v[92:93], v45 offset:45056
    v_mfma_f32_16x16x32_bf16 v[100:103], v[72:75], v[156:159], v[100:103]
    ds_read_b64_tr_b16 v[94:95], v45 offset:45568
    s_waitcnt lgkmcnt(6)
    v_mfma_f32_16x16x32_bf16 v[96:99], v[80:83], v[160:163], v[96:99]
    ds_read_b64_tr_b16 v[64:65], v44 offset:32768
    s_waitcnt lgkmcnt(5)
    v_mfma_f32_16x16x32_bf16 v[104:107], v[84:87], v[160:163], v[104:107]
    ds_read_b64_tr_b16 v[66:67], v44 offset:33280
    v_mfma_f32_16x16x32_bf16 v[108:111], v[84:87], v[164:167], v[108:111]
    ds_read_b64_tr_b16 v[68:69], v45 offset:32768
    v_mfma_f32_16x16x32_bf16 v[100:103], v[80:83], v[164:167], v[100:103]
    ds_read_b64_tr_b16 v[70:71], v45 offset:33280
    s_waitcnt lgkmcnt(6)
    v_mfma_f32_16x16x32_bf16 v[96:99], v[88:91], v[168:171], v[96:99]
    ds_read_b64_tr_b16 v[72:73], v44 offset:36864
    s_waitcnt lgkmcnt(5)
    v_mfma_f32_16x16x32_bf16 v[104:107], v[92:95], v[168:171], v[104:107]
    ds_read_b64_tr_b16 v[74:75], v44 offset:37376
    v_mfma_f32_16x16x32_bf16 v[108:111], v[92:95], v[172:175], v[108:111]
    ds_read_b64_tr_b16 v[76:77], v45 offset:36864
    v_mfma_f32_16x16x32_bf16 v[100:103], v[88:91], v[172:175], v[100:103]
    ds_read_b64_tr_b16 v[78:79], v45 offset:37376
    s_waitcnt lgkmcnt(6)
    v_mfma_f32_16x16x32_bf16 v[96:99], v[64:67], v[176:179], v[96:99]
    ds_read_b64_tr_b16 v[80:81], v44 offset:24576
    s_waitcnt lgkmcnt(5)
    v_mfma_f32_16x16x32_bf16 v[104:107], v[68:71], v[176:179], v[104:107]
    ds_read_b64_tr_b16 v[82:83], v44 offset:25088
    v_mfma_f32_16x16x32_bf16 v[108:111], v[68:71], v[180:183], v[108:111]
    ds_read_b64_tr_b16 v[84:85], v45 offset:24576
    v_mfma_f32_16x16x32_bf16 v[100:103], v[64:67], v[180:183], v[100:103]
    ds_read_b64_tr_b16 v[86:87], v45 offset:25088
    s_waitcnt lgkmcnt(6)
    v_mfma_f32_16x16x32_bf16 v[96:99], v[72:75], v[184:187], v[96:99]
    ds_read_b64_tr_b16 v[88:89], v44 offset:28672
    s_waitcnt lgkmcnt(5)
    v_mfma_f32_16x16x32_bf16 v[104:107], v[76:79], v[184:187], v[104:107]
    ds_read_b64_tr_b16 v[90:91], v44 offset:29184
    v_mfma_f32_16x16x32_bf16 v[108:111], v[76:79], v[188:191], v[108:111]
    ds_read_b64_tr_b16 v[92:93], v45 offset:28672
    v_mfma_f32_16x16x32_bf16 v[100:103], v[72:75], v[188:191], v[100:103]
    ds_read_b64_tr_b16 v[94:95], v45 offset:29184
    s_waitcnt lgkmcnt(6)
    v_mfma_f32_16x16x32_bf16 v[96:99], v[80:83], v[192:195], v[96:99]
    ds_read_b64_tr_b16 v[64:65], v44 offset:16384
    s_waitcnt lgkmcnt(5)
    v_mfma_f32_16x16x32_bf16 v[104:107], v[84:87], v[192:195], v[104:107]
    ds_read_b64_tr_b16 v[66:67], v44 offset:16896
    v_mfma_f32_16x16x32_bf16 v[108:111], v[84:87], v[196:199], v[108:111]
    ds_read_b64_tr_b16 v[68:69], v45 offset:16384
    v_mfma_f32_16x16x32_bf16 v[100:103], v[80:83], v[196:199], v[100:103]
    ds_read_b64_tr_b16 v[70:71], v45 offset:16896
    s_waitcnt lgkmcnt(6)
    v_mfma_f32_16x16x32_bf16 v[96:99], v[88:91], v[200:203], v[96:99]
    ds_read_b64_tr_b16 v[72:73], v44 offset:20480
    s_waitcnt lgkmcnt(5)
    v_mfma_f32_16x16x32_bf16 v[104:107], v[92:95], v[200:203], v[104:107]
    ds_read_b64_tr_b16 v[74:75], v44 offset:20992
    v_mfma_f32_16x16x32_bf16 v[108:111], v[92:95], v[204:207], v[108:111]
    ds_read_b64_tr_b16 v[76:77], v45 offset:20480
    v_mfma_f32_16x16x32_bf16 v[100:103], v[88:91], v[204:207], v[100:103]
    ds_read_b64_tr_b16 v[78:79], v45 offset:20992
    s_barrier
    s_waitcnt lgkmcnt(6)
    v_mfma_f32_16x16x32_bf16 v[96:99], v[64:67], v[208:211], v[96:99]
    ds_read_b64_tr_b16 v[80:81], v44 offset:8192
    s_waitcnt lgkmcnt(5)
    v_mfma_f32_16x16x32_bf16 v[104:107], v[68:71], v[208:211], v[104:107]
    ds_read_b64_tr_b16 v[82:83], v44 offset:8704
    v_mfma_f32_16x16x32_bf16 v[108:111], v[68:71], v[212:215], v[108:111]
    ds_read_b64_tr_b16 v[84:85], v45 offset:8192
    v_mfma_f32_16x16x32_bf16 v[100:103], v[64:67], v[212:215], v[100:103]
    ds_read_b64_tr_b16 v[86:87], v45 offset:8704
    s_waitcnt lgkmcnt(6)
    v_mfma_f32_16x16x32_bf16 v[96:99], v[72:75], v[216:219], v[96:99]
    ds_read_b64_tr_b16 v[88:89], v44 offset:12288
    s_waitcnt lgkmcnt(5)
    v_mfma_f32_16x16x32_bf16 v[104:107], v[76:79], v[216:219], v[104:107]
    ds_read_b64_tr_b16 v[90:91], v44 offset:12800
    v_mfma_f32_16x16x32_bf16 v[108:111], v[76:79], v[220:223], v[108:111]
    ds_read_b64_tr_b16 v[92:93], v45 offset:12288
    v_mfma_f32_16x16x32_bf16 v[100:103], v[72:75], v[220:223], v[100:103]
    ds_read_b64_tr_b16 v[94:95], v45 offset:12800
    s_waitcnt lgkmcnt(6)
    v_mfma_f32_16x16x32_bf16 v[96:99], v[80:83], v[224:227], v[96:99]
    ds_read_b64_tr_b16 v[64:65], v44 offset:0
    s_waitcnt lgkmcnt(5)
    v_mfma_f32_16x16x32_bf16 v[104:107], v[84:87], v[224:227], v[104:107]
    ds_read_b64_tr_b16 v[66:67], v44 offset:512
    v_mfma_f32_16x16x32_bf16 v[108:111], v[84:87], v[228:231], v[108:111]
    ds_read_b64_tr_b16 v[68:69], v45 offset:0
    v_mfma_f32_16x16x32_bf16 v[100:103], v[80:83], v[228:231], v[100:103]
    ds_read_b64_tr_b16 v[70:71], v45 offset:512
    s_waitcnt lgkmcnt(6)
    v_mfma_f32_16x16x32_bf16 v[96:99], v[88:91], v[232:235], v[96:99]
    ds_read_b64_tr_b16 v[72:73], v44 offset:4096
    s_waitcnt lgkmcnt(5)
    v_mfma_f32_16x16x32_bf16 v[104:107], v[92:95], v[232:235], v[104:107]
    ds_read_b64_tr_b16 v[74:75], v44 offset:4608
    v_mfma_f32_16x16x32_bf16 v[108:111], v[92:95], v[236:239], v[108:111]
    ds_read_b64_tr_b16 v[76:77], v45 offset:4096
    v_mfma_f32_16x16x32_bf16 v[100:103], v[88:91], v[236:239], v[100:103]
    ds_read_b64_tr_b16 v[78:79], v45 offset:4608
    s_waitcnt lgkmcnt(6)
    v_mfma_f32_16x16x32_bf16 v[96:99], v[64:67], v[240:243], v[96:99]
    s_waitcnt lgkmcnt(4)
    v_mfma_f32_16x16x32_bf16 v[104:107], v[68:71], v[240:243], v[104:107]
    v_mfma_f32_16x16x32_bf16 v[108:111], v[68:71], v[244:247], v[108:111]
    v_mfma_f32_16x16x32_bf16 v[100:103], v[64:67], v[244:247], v[100:103]
    s_waitcnt lgkmcnt(2)
    v_mfma_f32_16x16x32_bf16 v[96:99], v[72:75], v[248:251], v[96:99]
    s_waitcnt lgkmcnt(0)
    v_mfma_f32_16x16x32_bf16 v[104:107], v[76:79], v[248:251], v[104:107]
    v_mfma_f32_16x16x32_bf16 v[108:111], v[76:79], v[252:255], v[108:111]
    v_mfma_f32_16x16x32_bf16 v[100:103], v[72:75], v[252:255], v[100:103]
    s_setprio 0
    s_cmp_eq_u32 s66, 7
    s_cbranch_scc1 L_red
    s_nop 0
    v_cvt_pk_bf16_f32 v36, v96, v97
    v_cvt_pk_bf16_f32 v37, v98, v99
    s_nop 1
    v_cvt_pk_bf16_f32 v38, v100, v101
    v_cvt_pk_bf16_f32 v39, v102, v103
    v_cvt_pk_bf16_f32 v40, v104, v105
    v_cvt_pk_bf16_f32 v41, v106, v107
    v_cvt_pk_bf16_f32 v42, v108, v109
    v_cvt_pk_bf16_f32 v43, v110, v111
    v_permlane16_swap_b32 v36, v38
    v_permlane16_swap_b32 v37, v39
    v_permlane16_swap_b32 v40, v42
    v_permlane16_swap_b32 v41, v43
    v_cndmask_b32 v42, v42, 0, s[90:91]
    v_mfma_f32_32x32x16_bf16 v[112:127], v[24:27], v[36:39], 0
    s_nop 0
    v_mfma_f32_32x32x16_bf16 v[112:127], v[28:31], v[40:43], v[112:127]
    v_mul_f32 v4, 0xbfb8aa3b, v108
    v_mul_f32 v12, 0xbfb8aa3b, v104
    s_nop 1
    v_permlane16_swap_b32 v12, v4
    v_mov_b32 v12, v4
    s_nop 1
    v_permlane32_swap_b32 v12, v4
    v_exp_f32 v4, v4
    s_nop 0
    v_add_f32 v4, 1.0, v4
    v_rcp_f32 v4, v4
    v_exp_f32_e64 v128, -v112
    v_exp_f32 v112, v112
    v_exp_f32_e64 v129, -v113
    v_exp_f32 v113, v113
    v_exp_f32_e64 v130, -v114
    v_exp_f32 v114, v114
    v_exp_f32_e64 v131, -v115
    v_exp_f32 v115, v115
    v_exp_f32_e64 v132, -v116
    v_exp_f32 v116, v116
    v_exp_f32_e64 v133, -v117
    v_exp_f32 v117, v117
    v_exp_f32_e64 v134, -v118
    v_exp_f32 v118, v118
    v_exp_f32_e64 v135, -v126
    v_exp_f32 v119, v126
    v_exp_f32_e64 v136, -v120
    v_exp_f32 v120, v120
    v_exp_f32_e64 v137, -v121
    v_exp_f32 v121, v121
    v_exp_f32_e64 v138, -v122
    v_exp_f32 v122, v122
    v_exp_f32_e64 v139, -v123
    v_exp_f32 v123, v123
    v_exp_f32_e64 v140, -v124
    v_exp_f32 v124, v124
    v_exp_f32_e64 v141, -v125
    v_exp_f32 v125, v125
    v_add_f32 v18, v112, v114
    v_add_f32 v19, v113, v115
    v_add_f32 v20, v128, v130
    v_add_f32 v21, v129, v131
    v_add_f32 v18, v18, v116
    v_add_f32 v19, v19, v117
    v_add_f32 v20, v20, v132
    v_add_f32 v21, v21, v133
    v_add_f32 v18, v18, v118
    v_add_f32 v19, v19, v119
    v_add_f32 v20, v20, v134
    v_add_f32 v21, v21, v135
    v_add_f32 v18, v18, v120
    v_add_f32 v19, v19, v121
    v_add_f32 v20, v20, v136
    v_add_f32 v21, v21, v137
    v_add_f32 v18, v18, v122
    v_add_f32 v19, v19, v123
    v_add_f32 v20, v20, v138
    v_add_f32 v21, v21, v139
    v_add_f32 v18, v18, v124
    v_add_f32 v19, v19, v125
    v_add_f32 v20, v20, v140
    v_add_f32 v21, v21, v141
    v_add_f32 v12, v18, v19
    v_add_f32 v13, v20, v21
    s_nop 1
    v_permlane32_swap_b32 v12, v13
    v_add_f32 v12, v12, v13
    v_subrev_u32 v13, 0xf800000, v12
    v_cmp_le_u32 vcc, 0x6c000000, v13
    s_mov_b32 s98, 3
    s_cbranch_vccnz L_phixq
L_phir_q1:
    v_rcp_f32 v14, v12
    s_nop 0
    v_mov_b32 v16, v14
    s_nop 1
    v_permlane32_swap_b32 v14, v16
    v_mul_f32 v112, v112, v14
    v_mul_f32 v113, v113, v14
    v_cvt_pk_bf16_f32 v64, v112, v113
    v_mul_f32 v128, v128, v16
    v_mul_f32 v129, v129, v16
    v_cvt_pk_bf16_f32 v72, v128, v129
    v_mul_f32 v114, v114, v14
    v_mul_f32 v115, v115, v14
    v_cvt_pk_bf16_f32 v65, v114, v115
    v_mul_f32 v130, v130, v16
    v_mul_f32 v131, v131, v16
    v_cvt_pk_bf16_f32 v73, v130, v131
    v_mul_f32 v116, v116, v14
    v_mul_f32 v117, v117, v14
    v_cvt_pk_bf16_f32 v66, v116, v117
    v_mul_f32 v132, v132, v16
    v_mul_f32 v133, v133, v16
    v_cvt_pk_bf16_f32 v74, v132, v133
    v_mul_f32 v118, v118, v14
    v_mul_f32 v119, v119, v14
    v_cvt_pk_bf16_f32 v67, v118, 0
    v_mul_f32 v134, v134, v16
    v_mul_f32 v135, v135, v16
    v_cvt_pk_bf16_f32 v75, v134, 0
    v_mul_f32 v120, v120, v14
    v_mul_f32 v121, v121, v14
    v_cvt_pk_bf16_f32 v68, v120, v121
    v_mul_f32 v136, v136, v16
    v_mul_f32 v137, v137, v16
    v_cvt_pk_bf16_f32 v76, v136, v137
    v_mul_f32 v122, v122, v14
    v_mul_f32 v123, v123, v14
    v_cvt_pk_bf16_f32 v69, v122, v123
    v_mul_f32 v138, v138, v16
    v_mul_f32 v139, v139, v16
    v_cvt_pk_bf16_f32 v77, v138, v139
    v_mul_f32 v124, v124, v14
    v_mul_f32 v125, v125, v14
    v_cvt_pk_bf16_f32 v70, v124, v125
    v_mul_f32 v140, v140, v16
    v_mul_f32 v141, v141, v16
    v_cvt_pk_bf16_f32 v78, v140, v141
    v_cvt_pk_bf16_f32 v71, v119, 0
    v_cvt_pk_bf16_f32 v79, v135, 0
L_redj:
    s_barrier
    s_load_dwordx4 s[28:31], s[56:57], s64 glc
    s_load_dwordx4 s[32:35], s[56:57], s70 glc
L_rk1:
    buffer_load_dwordx4 v[80:83], v11, s[36:39], s18 offen offset:0 sc1
    buffer_load_dwordx4 v[84:87], v11, s[36:39], s18 offen offset:1024 sc1
    buffer_load_dwordx4 v[88:91], v11, s[36:39], s18 offen offset:2048 sc1
    buffer_load_dwordx4 v[92:95], v11, s[36:39], s18 offen offset:3072 sc1
    s_waitcnt vmcnt(3)
    v_xor_b32 v83, s58, v83
    v_mov_b32 v14, v83
    s_nop 0
    v_mfma_f32_32x32x16_bf16 v[112:127], v[80:83], v[64:67], 0
    s_waitcnt vmcnt(2)
    v_xor_b32 v87, s58, v87
    v_or_b32 v14, v14, v87
    s_nop 0
    v_mfma_f32_32x32x16_bf16 v[112:127], v[84:87], v[68:71], v[112:127]
    s_waitcnt vmcnt(1)
    v_xor_b32 v91, s58, v91
    v_or_b32 v14, v14, v91
    s_nop 0
    v_mfma_f32_32x32x16_bf16 v[112:127], v[88:91], v[72:75], v[112:127]
    s_waitcnt vmcnt(0)
    v_xor_b32 v95, s58, v95
    v_or_b32 v14, v14, v95
    s_nop 0
    v_mfma_f32_32x32x16_bf16 v[112:127], v[92:95], v[76:79], v[112:127]
    v_cmp_lt_u32 vcc, 0xffff, v14
    s_add_u32 s59, s59, 1
    s_cmp_gt_u32 s59, 100000
    s_cbranch_scc1 L_rk1_ok
    s_cbranch_vccnz L_rk1
L_rk1_ok:
    s_nop 6
    s_nop 0
    v_add_f32 v119, 0x358637bd, v119
    v_rcp_f32 v12, v119
    s_nop 0
    v_mul_f32 v12, v12, v4
    v_mul_f32 v112, v112, v12
    v_mul_f32 v113, v113, v12
    v_cvt_pk_bf16_f32 v128, v112, v113
    v_mul_f32 v114, v114, v12
    v_mul_f32 v115, v115, v12
    v_cvt_pk_bf16_f32 v129, v114, v115
    v_mul_f32 v116, v116, v12
    v_mul_f32 v117, v117, v12
    v_cvt_pk_bf16_f32 v130, v116, v117
    v_mul_f32 v118, v118, v12
    v_cvt_pk_bf16_f32 v131, v118, 0
    v_or_b32 v131, s58, v131
    buffer_store_dwordx4 v[128:131], v5, s[36:39], 0 offen offset:0 sc1
    v_mul_f32 v120, v120, v12
    v_mul_f32 v121, v121, v12
    v_cvt_pk_bf16_f32 v132, v120, v121
    v_mul_f32 v122, v122, v12
    v_mul_f32 v123, v123, v12
    v_cvt_pk_bf16_f32 v133, v122, v123
    v_mul_f32 v124, v124, v12
    v_mul_f32 v125, v125, v12
    v_cvt_pk_bf16_f32 v134, v124, v125
    v_mul_f32 v126, v126, v12
    v_cvt_pk_bf16_f32 v135, v126, 0
    v_or_b32 v135, s58, v135
    buffer_store_dwordx4 v[132:135], v5, s[36:39], 0 offen offset:1024 sc1
    v_mov_b32 v20, s1
    v_mov_b32 v21, s26
    s_mov_b64 exec, 1
    buffer_store_dword v21, v20, s[36:39], 0 offen sc1
    s_mov_b64 exec, -1
    s_barrier
    s_cmp_eq_u32 s21, 0
    s_cbranch_scc1 L_tailb
    s_mov_b32 s74, 0
    s_mov_b32 s93, 0
    s_waitcnt lgkmcnt(0)
    s_branch L_p3_chk
L_pathB:
    s_add_u32 m0, s72, 55552
    s_nop 0
    buffer_load_dwordx4 v34, s[32:35], s80 offen offset:1792 lds
    s_add_u32 s87, s70, 1
    s_sub_u32 s88, s87, 7
    s_min_u32 s87, s87, s88
    s_lshl_b32 s74, s87, 7
    s_mul_i32 s81, s87, 172032
    s_add_u32 m0, s71, 81920
    s_nop 0
    buffer_load_dwordx4 v32, s[28:31], s74 offen offset:0 lds
    buffer_load_dwordx4 v33, s[28:31], s74 offen offset:1024 lds
    s_bfe_u32 s60, s2, 0x20001
    s_and_b32 s64, s2, 1
    s_xor_b32 s64, s64, 1
    s_lshl2_add_u32 s60, s64, s60
    s_mov_b32 s38, 0xb00000
    s_mov_b32 s39, 0x20000
    s_mov_b32 s43, 0x20000
    s_mov_b32 s47, 0x20000
    s_mov_b32 s50, 1835008
    s_mov_b32 s51, 0x20000
    s_mov_b32 s54, 25088
    s_mov_b32 s55, 0x20000
    s_cmp_ge_u32 s61, 4
    s_cselect_b32 s42, 401408, 0
    s_cselect_b32 s46, 401408, 0
    s_cselect_b32 s21, 1, 0
    s_mov_b32 s59, 0
    s_mov_b32 s90, 0
    s_mov_b32 s91, -1
    s_mov_b32 s8, 0xf7f77f7f
    s_bitcmp1_b32 s66, 0
    s_cselect_b32 s8, 0xfdfddfdf, s8
    s_mov_b32 s9, s8
    s_mov_b32 s10, -1
    s_mov_b32 s11, 0xffff
    s_mov_b32 s12, 0x77ff77ff
    s_mov_b32 s13, 0x77ff77ff
    s_lshr_b32 s96, s66, 2
    s_bfe_u32 s67, s66, 0x10001
    s_and_b32 s68, s66, 1
    s_lshl1_add_u32 s69, s62, s68
    s_lshl1_add_u32 s3, s67, s96
    s_lshl2_add_u32 s14, s65, s3
    v_lshlrev_b32 v1, 4, v13
    s_add_u32 s87, s70, 2
    s_sub_u32 s88, s87, 7
    s_min_u32 s87, s87, s88
    s_lshl_b32 s75, s87, 7
    s_mul_i32 s82, s87, 172032
    s_add_u32 s87, s70, 3
    s_sub_u32 s88, s87, 7
    s_min_u32 s87, s87, s88
    s_lshl_b32 s76, s87, 7
    s_mul_i32 s83, s87, 172032
    s_add_u32 s87, s70, 4
    s_sub_u32 s88, s87, 7
    s_min_u32 s87, s87, s88
    s_lshl_b32 s77, s87, 7
    s_mul_i32 s84, s87, 172032
    s_add_u32 s87, s70, 5
    s_sub_u32 s88, s87, 7
    s_min_u32 s87, s87, s88
    s_lshl_b32 s78, s87, 7
    s_mul_i32 s85, s87, 172032
    s_add_u32 s87, s70, 6
    s_sub_u32 s88, s87, 7
    s_min_u32 s87, s87, s88
    s_lshl_b32 s79, s87, 7
    s_mul_i32 s86, s87, 172032
    s_lshl_b32 s87, s70, 6
    v_subrev_u32 v18, s87, v26
    v_add_u32 v19, 448, v18
    v_min_u32 v18, v18, v19
    v_bfe_u32 v19, v18, 1, 1
    v_lshlrev_b32 v19, 6, v19
    v_xor_b32 v19, 112, v19
    v_and_b32 v20, 8, v18
    v_lshlrev_b32 v20, 2, v20
    v_xor_b32 v19, v19, v20
    v_xor_b32 v18, 0x1c0, v18
    v_subrev_u32 v18, 64, v18
    v_lshl_add_u32 v27, v18, 7, v19
    v_mov_b32 v29, 0
    v_mov_b32 v31, 0
    s_max_u32 s87, s61, 4
    s_sub_u32 s87, s87, 4
    s_mul_i32 s88, s87, 37
    s_lshr_b32 s88, s88, 8
    s_lshl2_add_u32 s20, s60, s88
    s_mul_i32 s88, s88, 7
    s_sub_u32 s19, s87, s88
    s_and_b32 s87, s66, 3
    s_mul_i32 s87, s87, 14336
    s_lshl_b32 s88, s19, 7
    s_add_u32 s87, s87, s88
    v_mul_u32_u24 v18, 896, v14
    v_lshlrev_b32 v17, 1, v16
    v_xor_b32 v17, v17, v15
    v_lshl_add_u32 v18, v17, 4, v18
    v_add_u32 v2, s87, v18
    v_add_u32 v3, 6144, v2
    s_lshl_b32 s87, s63, 6
    s_add_u32 s87, s87, s14
    s_lshl4_add_u32 s87, s87, s69
    s_lshl_b32 s88, s87, 11
    s_add_u32 s88, s88, 0x600000
    v_add_u32 v5, s88, v1
    s_lshr_b32 s88, s87, 2
    s_lshl_b32 s88, s88, 5
    s_and_b32 s87, s87, 3
    s_add_u32 s87, s87, s88
    s_lshl2_add_u32 s1, s87, 0x60000
    v_lshrrev_b32 v12, 4, v13
    v_and_b32 v14, 15, v13
    v_bfe_u32 v18, v13, 1, 3
    v_xor_b32 v18, v18, v12
    v_lshlrev_b32 v18, 4, v18
    v_lshl_add_u32 v18, v14, 7, v18
    s_lshl_b32 s87, s3, 12
    s_add_u32 s87, s87, 57344
    v_add_u32 v36, s87, v18
    v_xor_b32 v37, 64, v36
    v_add_u32 v38, 57344, v36
    v_add_u32 v39, 57344, v37
    v_and_b32 v14, 31, v13
    v_lshrrev_b32 v15, 5, v13
    v_bfe_u32 v16, v13, 2, 2
    v_bfe_u32 v17, v13, 4, 1
    v_and_b32 v21, 3, v13
    v_lshrrev_b32 v20, 1, v16
    v_lshl_add_u32 v20, v20, 1, v17
    v_lshlrev_b32 v20, 5, v20
    v_lshl_add_u32 v17, v17, 2, v21
    v_lshl_add_u32 v19, v12, 3, v16
    v_lshlrev_b32 v19, 7, v19
    s_mul_i32 s87, s68, 56
    s_lshl_b32 s88, s68, 3
    s_sub_u32 s88, 120, s88
    v_lshl_add_u32 v18, v21, 3, s87
    v_xor_b32 v44, v18, v20
    v_add_u32 v44, v44, v19
    v_cmp_eq_u32 vcc, 3, v21
    v_add_u32 v18, 32, v18
    v_mov_b32 v45, s88
    v_cndmask_b32 v18, v18, v45, vcc
    v_xor_b32 v18, v18, v20
    v_add_u32 v45, v18, v19
    s_lshl_b32 s87, s68, 6
    v_lshl_add_u32 v18, v21, 3, s87
    v_xor_b32 v18, v18, v20
    v_add_u32 v18, v18, v19
    v_add_u32 v40, 57344, v18
    v_xor_b32 v41, 32, v40
    v_add_u32 v42, 114688, v18
    v_xor_b32 v43, 32, v42
    v_lshlrev_b32 v18, 2, v15
    v_sub_u32 v18, v14, v18
    v_mov_b32 v19, 0xf149f2ca
    v_cmp_le_i32 vcc, 0, v18
    v_cmp_le_i32 s[94:95], 1, v18
    s_nop 0
    v_cndmask_b32_e64 v128, v19, 0, vcc
    v_cndmask_b32_e64 v112, 0, v19, vcc
    v_cndmask_b32_e64 v129, v19, 0, s[94:95]
    v_cndmask_b32_e64 v113, 0, v19, s[94:95]
    v_cmp_le_i32 vcc, 2, v18
    v_cmp_le_i32 s[94:95], 3, v18
    s_nop 0
    v_cndmask_b32_e64 v130, v19, 0, vcc
    v_cndmask_b32_e64 v114, 0, v19, vcc
    v_cndmask_b32_e64 v131, v19, 0, s[94:95]
    v_cndmask_b32_e64 v115, 0, v19, s[94:95]
    v_cmp_le_i32 vcc, 16, v18
    v_cmp_le_i32 s[94:95], 17, v18
    s_nop 0
    v_cndmask_b32_e64 v132, v19, 0, vcc
    v_cndmask_b32_e64 v116, 0, v19, vcc
    v_cndmask_b32_e64 v133, v19, 0, s[94:95]
    v_cndmask_b32_e64 v117, 0, v19, s[94:95]
    v_cmp_le_i32 vcc, 18, v18
    v_cmp_le_i32 s[94:95], 19, v18
    s_nop 0
    v_cndmask_b32_e64 v134, v19, 0, vcc
    v_cndmask_b32_e64 v118, 0, v19, vcc
    v_cndmask_b32_e64 v135, v19, 0, s[94:95]
    v_cndmask_b32_e64 v119, 0, v19, s[94:95]
    v_cmp_le_i32 vcc, 8, v18
    v_cmp_le_i32 s[94:95], 9, v18
    s_nop 0
    v_cndmask_b32_e64 v136, v19, 0, vcc
    v_cndmask_b32_e64 v120, 0, v19, vcc
    v_cndmask_b32_e64 v137, v19, 0, s[94:95]
    v_cndmask_b32_e64 v121, 0, v19, s[94:95]
    v_cmp_le_i32 vcc, 10, v18
    v_cmp_le_i32 s[94:95], 11, v18
    s_nop 0
    v_cndmask_b32_e64 v138, v19, 0, vcc
    v_cndmask_b32_e64 v122, 0, v19, vcc
    v_cndmask_b32_e64 v139, v19, 0, s[94:95]
    v_cndmask_b32_e64 v123, 0, v19, s[94:95]
    v_cmp_le_i32 vcc, 24, v18
    v_cmp_le_i32 s[94:95], 25, v18
    s_nop 0
    v_cndmask_b32_e64 v140, v19, 0, vcc
    v_cndmask_b32_e64 v124, 0, v19, vcc
    v_cndmask_b32_e64 v141, v19, 0, s[94:95]
    v_cndmask_b32_e64 v125, 0, v19, s[94:95]
    v_cmp_le_i32 vcc, 26, v18
    v_cmp_le_i32 s[94:95], 27, v18
    s_nop 0
    v_cndmask_b32_e64 v142, v19, 0, vcc
    v_cndmask_b32_e64 v126, 0, v19, vcc
    v_cndmask_b32_e64 v143, v19, 0, s[94:95]
    v_cndmask_b32_e64 v127, 0, v19, s[94:95]
    s_mul_i32 s87, s14, 28672
    s_lshl_b32 s88, s69, 11
    s_add_u32 s88, s88, s87
    s_add_u32 s88, s88, 0x100000
    s_lshl_b32 s89, s69, 9
    s_add_u32 s22, s89, s87
    s_add_u32 s22, s22, 0x300000
    s_cmp_eq_u32 s62, 7
    s_cselect_b32 s88, 0x7f000000, s88
    s_cselect_b32 s22, 0x7f000000, s22
    v_add_u32 v46, s88, v1
    s_lshl3_add_u32 s89, s65, s62
    s_lshl_b32 s89, s89, 7
    s_lshl_b32 s87, s96, 15
    s_add_u32 s89, s89, s87
    s_add_u32 s0, s89, 131072
    v_mul_u32_u24 v18, 6912, v12
    v_add_u32 v11, v18, v1
    v_mul_u32_u24 v18, 7168, v15
    v_and_b32 v20, 15, v14
    v_add_u32 v20, 4, v20
    v_lshrrev_b32 v20, 4, v20
    v_sub_u32 v19, v14, v20
    v_lshrrev_b32 v20, 4, v14
    v_lshlrev_b32 v20, 1, v20
    v_sub_u32 v19, v19, v20
    v_lshl_add_u32 v9, v19, 4, v18
    s_mov_b32 s24, 0
    s_mov_b32 s25, 57344
    s_mul_i32 s89, s68, 24576
    s_lshl_b32 s88, s3, 11
    s_add_u32 s18, s88, s89
    s_add_u32 s88, s18, 57344
    v_add_u32 v10, s88, v1
    s_and_b32 s87, s66, 3
    s_lshl_b32 s16, s87, 13
    s_add_u32 s87, s87, s65
    s_sub_u32 s88, s87, 2
    s_mul_i32 s15, s88, 114688
    s_cmp_ge_u32 s87, 2
    s_cselect_b32 s15, s15, 0x7f000000
    s_cselect_b32 s88, s88, s65
    s_lshl_b32 s88, s88, 10
    s_lshl_b32 s89, s96, 15
    s_add_u32 s88, s88, s89
    s_add_u32 s88, s88, 131072
    s_add_u32 s100, s36, s88
    s_addc_u32 s101, s37, 0
    s_max_u32 s92, s62, 1
    s_sub_u32 s92, s92, 1
    s_lshl_b32 s92, s92, 7
    s_lshl_b32 s94, s62, 7
    s_add_u32 s94, s94, 0
    s_bitcmp1_b32 136, s66
    s_cselect_b32 s87, s0, s1
    v_mov_b32 v12, s1
    v_writelane_b32 v12, s87, 1
    v_writelane_b32 v12, s87, 3
    v_and_b32 v13, 2, v0
    v_lshl_add_u32 v12, v13, 18, v12
    s_mov_b64 exec, 3
    buffer_store_dword v29, v12, s[36:39], 0 offen sc1
    s_mov_b64 exec, -1
    v_bfe_u32 v16, v0, 2, 2
    v_and_b32 v17, 3, v0
    s_and_b32 s98, s66, 3
    s_mul_i32 s87, s98, 14336
    v_lshl_add_u32 v17, v17, 3, s87
    v_bfe_u32 v19, v0, 5, 1
    v_bfe_u32 v20, v0, 4, 1
    v_lshl_add_u32 v18, v20, 2, v16
    v_mad_u32_u24 v18, v19, 14, v18
    v_lshl_add_u32 v6, v18, 7, v17
    v_bfe_u32 v18, v18, 1, 2
    v_xor_b32 v18, s98, v18
    v_lshl_add_u32 v6, v18, 5, v6
    v_min_u32 v16, 2, v16
    v_mad_u32_u24 v18, v20, 3, v16
    v_mad_u32_u24 v18, v19, 14, v18
    v_lshl_add_u32 v7, v18, 7, v17
    v_bfe_u32 v18, v18, 1, 2
    v_xor_b32 v18, s98, v18
    v_lshl_add_u32 v7, v18, 5, v7
    s_bfe_u32 s87, s19, 0x10008
    s_xor_b32 s87, s87, s96
    s_lshl1_add_u32 s87, s20, s87
    s_mul_i32 s88, s87, 28672
    s_lshl2_add_u32 s89, s19, s98
    s_lshl_b32 s89, s89, 5
    s_add_u32 s88, s88, s89
    v_and_b32 v16, 31, v0
    v_mul_u32_u24 v16, 896, v16
    v_lshl_add_u32 v16, v19, 4, v16
    v_add_u32 v8, s88, v16
    s_lshl2_add_u32 s87, s87, s98
    s_lshl_b32 s20, s87, 13
    s_add_u32 s20, s20, 0x600000
    s_lshl_b32 s87, s87, 7
    s_add_u32 s87, s87, 393216
    s_and_b32 s19, s19, 1
    s_lshl_b32 s88, s19, 19
    s_add_u32 s87, s87, 0
    s_add_u32 s56, s36, s87
    s_addc_u32 s57, s37, 0
    s_lshl_b32 s64, s19, 15
    s_xor_b32 s70, s64, 32768
    s_add_u32 m0, s72, 97408
    s_nop 0
    buffer_load_dwordx4 v34, s[32:35], s81 offen offset:896 lds
    s_add_u32 m0, s72, 63744
    s_nop 0
    buffer_load_dwordx4 v34, s[32:35], s81 offen offset:1792 lds
    s_waitcnt lgkmcnt(0)
    s_mul_i32 s26, s26, 1664525
    s_add_u32 s26, s26, 1013904223
    s_or_b32 s26, s26, 1
    s_mov_b32 s27, s26
    s_lshl_b32 s58, s26, 16
    s_waitcnt vmcnt(9)
    v_mov_b32 v30, v28
    ds_write_b128 v27, v[28:31]
    s_waitcnt vmcnt(5)
    s_barrier
    ds_read_b64_tr_b16 v[64:65], v42 offset:32768
    s_add_u32 m0, s71, 106496
    s_nop 0
    buffer_load_dwordx4 v32, s[28:31], s75 offen offset:0 lds
    ds_read_b64_tr_b16 v[66:67], v42 offset:33280
    ds_read_b128 v[144:147], v38 offset:16384
    ds_read_b64_tr_b16 v[68:69], v43 offset:32768
    ds_read_b64_tr_b16 v[70:71], v43 offset:33280
    ds_read_b128 v[148:151], v38 offset:18432
    ds_read_b64_tr_b16 v[72:73], v42 offset:36864
    ds_read_b64_tr_b16 v[74:75], v42 offset:37376
    ds_read_b128 v[152:155], v39 offset:16384
    buffer_load_dwordx4 v33, s[28:31], s75 offen offset:1024 lds
    ds_read_b64_tr_b16 v[76:77], v43 offset:36864
    ds_read_b64_tr_b16 v[78:79], v43 offset:37376
    ds_read_b128 v[156:159], v39 offset:18432
    s_waitcnt lgkmcnt(9)
    v_mfma_f32_16x16x32_bf16 v[96:99], v[64:67], v[144:147], 0
    ds_read_b64_tr_b16 v[80:81], v40 offset:0
    s_add_u32 m0, s72, 121984
    s_nop 0
    buffer_load_dwordx4 v34, s[32:35], s82 offen offset:896 lds
    ds_read_b64_tr_b16 v[82:83], v40 offset:512
    s_waitcnt lgkmcnt(9)
    v_mfma_f32_16x16x32_bf16 v[104:107], v[68:71], v[144:147], 0
    ds_read_b64_tr_b16 v[84:85], v41 offset:0
    ds_read_b64_tr_b16 v[86:87], v41 offset:512
    s_waitcnt lgkmcnt(10)
    v_mfma_f32_16x16x32_bf16 v[108:111], v[68:71], v[148:151], 0
    ds_read_b64_tr_b16 v[88:89], v40 offset:4096
    v_mfma_f32_16x16x32_bf16 v[100:103], v[64:67], v[148:151], 0
    ds_read_b64_tr_b16 v[90:91], v40 offset:4608
    ds_read_b64_tr_b16 v[92:93], v41 offset:4096
    s_waitcnt lgkmcnt(10)
    v_mfma_f32_16x16x32_bf16 v[96:99], v[72:75], v[152:155], v[96:99]
    s_add_u32 m0, s72, 71936
    s_nop 0
    buffer_load_dwordx4 v34, s[32:35], s82 offen offset:1792 lds
    ds_read_b64_tr_b16 v[94:95], v41 offset:4608
    s_waitcnt lgkmcnt(9)
    v_mfma_f32_16x16x32_bf16 v[104:107], v[76:79], v[152:155], v[104:107]
    s_waitcnt lgkmcnt(8)
    v_mfma_f32_16x16x32_bf16 v[108:111], v[76:79], v[156:159], v[108:111]
    v_mfma_f32_16x16x32_bf16 v[100:103], v[72:75], v[156:159], v[100:103]
    s_waitcnt vmcnt(4) lgkmcnt(0)
    s_barrier
    v_mfma_f32_16x16x32_bf16 v[48:51], v[144:147], v[80:83], 0
    ds_read_b64_tr_b16 v[64:65], v40 offset:40960
    s_add_u32 m0, s71, 131072
    s_nop 0
    buffer_load_dwordx4 v32, s[28:31], s76 offen offset:0 lds
    ds_read_b64_tr_b16 v[66:67], v40 offset:41472
    v_mfma_f32_16x16x32_bf16 v[56:59], v[144:147], v[84:87], 0
    ds_read_b128 v[160:163], v36 offset:24576
    v_mfma_f32_16x16x32_bf16 v[60:63], v[148:151], v[84:87], 0
    ds_read_b64_tr_b16 v[68:69], v41 offset:40960
    ds_read_b64_tr_b16 v[70:71], v41 offset:41472
    v_mfma_f32_16x16x32_bf16 v[52:55], v[148:151], v[80:83], 0
    ds_read_b128 v[164:167], v36 offset:26624
    v_mfma_f32_16x16x32_bf16 v[48:51], v[152:155], v[88:91], v[48:51]
    ds_read_b64_tr_b16 v[72:73], v40 offset:45056
    ds_read_b64_tr_b16 v[74:75], v40 offset:45568
    v_mfma_f32_16x16x32_bf16 v[56:59], v[152:155], v[92:95], v[56:59]
    ds_read_b128 v[168:171], v37 offset:24576
    buffer_load_dwordx4 v33, s[28:31], s76 offen offset:1024 lds
    v_mfma_f32_16x16x32_bf16 v[60:63], v[156:159], v[92:95], v[60:63]
    ds_read_b64_tr_b16 v[76:77], v41 offset:45056
    ds_read_b64_tr_b16 v[78:79], v41 offset:45568
    v_mfma_f32_16x16x32_bf16 v[52:55], v[156:159], v[88:91], v[52:55]
    ds_read_b128 v[172:175], v37 offset:26624
    s_waitcnt lgkmcnt(9)
    v_mfma_f32_16x16x32_bf16 v[96:99], v[64:67], v[160:163], v[96:99]
    ds_read_b64_tr_b16 v[80:81], v40 offset:8192
    s_add_u32 m0, s72, 146560
    s_nop 0
    buffer_load_dwordx4 v34, s[32:35], s83 offen offset:896 lds
    ds_read_b64_tr_b16 v[82:83], v40 offset:8704
    s_waitcnt lgkmcnt(9)
    v_mfma_f32_16x16x32_bf16 v[104:107], v[68:71], v[160:163], v[104:107]
    ds_read_b64_tr_b16 v[84:85], v41 offset:8192
    ds_read_b64_tr_b16 v[86:87], v41 offset:8704
    s_waitcnt lgkmcnt(10)
    v_mfma_f32_16x16x32_bf16 v[108:111], v[68:71], v[164:167], v[108:111]
    ds_read_b64_tr_b16 v[88:89], v40 offset:12288
    v_mfma_f32_16x16x32_bf16 v[100:103], v[64:67], v[164:167], v[100:103]
    ds_read_b64_tr_b16 v[90:91], v40 offset:12800
    ds_read_b64_tr_b16 v[92:93], v41 offset:12288
    s_waitcnt lgkmcnt(10)
    v_mfma_f32_16x16x32_bf16 v[96:99], v[72:75], v[168:171], v[96:99]
    s_add_u32 m0, s72, 55552
    s_nop 0
    buffer_load_dwordx4 v34, s[32:35], s83 offen offset:1792 lds
    ds_read_b64_tr_b16 v[94:95], v41 offset:12800
    s_waitcnt lgkmcnt(9)
    v_mfma_f32_16x16x32_bf16 v[104:107], v[76:79], v[168:171], v[104:107]
    s_waitcnt lgkmcnt(8)
    v_mfma_f32_16x16x32_bf16 v[108:111], v[76:79], v[172:175], v[108:111]
    v_mfma_f32_16x16x32_bf16 v[100:103], v[72:75], v[172:175], v[100:103]
    s_waitcnt vmcnt(4) lgkmcnt(0)
    s_barrier
    v_mfma_f32_16x16x32_bf16 v[48:51], v[160:163], v[80:83], v[48:51]
    ds_read_b64_tr_b16 v[64:65], v42 offset:8192
    s_add_u32 m0, s71, 81920
    s_nop 0
    buffer_load_dwordx4 v32, s[28:31], s77 offen offset:0 lds
    ds_read_b64_tr_b16 v[66:67], v42 offset:8704
    v_mfma_f32_16x16x32_bf16 v[56:59], v[160:163], v[84:87], v[56:59]
    ds_read_b128 v[176:179], v36 offset:49152
    v_mfma_f32_16x16x32_bf16 v[60:63], v[164:167], v[84:87], v[60:63]
    ds_read_b64_tr_b16 v[68:69], v43 offset:8192
    ds_read_b64_tr_b16 v[70:71], v43 offset:8704
    v_mfma_f32_16x16x32_bf16 v[52:55], v[164:167], v[80:83], v[52:55]
    ds_read_b128 v[180:183], v36 offset:51200
    v_mfma_f32_16x16x32_bf16 v[48:51], v[168:171], v[88:91], v[48:51]
    ds_read_b64_tr_b16 v[72:73], v42 offset:12288
    ds_read_b64_tr_b16 v[74:75], v42 offset:12800
    v_mfma_f32_16x16x32_bf16 v[56:59], v[168:171], v[92:95], v[56:59]
    ds_read_b128 v[184:187], v37 offset:49152
    buffer_load_dwordx4 v33, s[28:31], s77 offen offset:1024 lds
    v_mfma_f32_16x16x32_bf16 v[60:63], v[172:175], v[92:95], v[60:63]
    ds_read_b64_tr_b16 v[76:77], v43 offset:12288
    ds_read_b64_tr_b16 v[78:79], v43 offset:12800
    v_mfma_f32_16x16x32_bf16 v[52:55], v[172:175], v[88:91], v[52:55]
    ds_read_b128 v[188:191], v37 offset:51200
    s_waitcnt lgkmcnt(9)
    v_mfma_f32_16x16x32_bf16 v[96:99], v[64:67], v[176:179], v[96:99]
    ds_read_b64_tr_b16 v[80:81], v40 offset:16384
    s_add_u32 m0, s72, 97408
    s_nop 0
    buffer_load_dwordx4 v34, s[32:35], s84 offen offset:896 lds
    ds_read_b64_tr_b16 v[82:83], v40 offset:16896
    s_waitcnt lgkmcnt(9)
    v_mfma_f32_16x16x32_bf16 v[104:107], v[68:71], v[176:179], v[104:107]
    ds_read_b64_tr_b16 v[84:85], v41 offset:16384
    ds_read_b64_tr_b16 v[86:87], v41 offset:16896
    s_waitcnt lgkmcnt(10)
    v_mfma_f32_16x16x32_bf16 v[108:111], v[68:71], v[180:183], v[108:111]
    ds_read_b64_tr_b16 v[88:89], v40 offset:20480
    v_mfma_f32_16x16x32_bf16 v[100:103], v[64:67], v[180:183], v[100:103]
    ds_read_b64_tr_b16 v[90:91], v40 offset:20992
    ds_read_b64_tr_b16 v[92:93], v41 offset:20480
    s_waitcnt lgkmcnt(10)
    v_mfma_f32_16x16x32_bf16 v[96:99], v[72:75], v[184:187], v[96:99]
    s_add_u32 m0, s72, 63744
    s_nop 0
    buffer_load_dwordx4 v34, s[32:35], s84 offen offset:1792 lds
    ds_read_b64_tr_b16 v[94:95], v41 offset:20992
    s_waitcnt lgkmcnt(9)
    v_mfma_f32_16x16x32_bf16 v[104:107], v[76:79], v[184:187], v[104:107]
    s_waitcnt lgkmcnt(8)
    v_mfma_f32_16x16x32_bf16 v[108:111], v[76:79], v[188:191], v[108:111]
    v_mfma_f32_16x16x32_bf16 v[100:103], v[72:75], v[188:191], v[100:103]
    s_waitcnt vmcnt(4) lgkmcnt(0)
    s_barrier
    v_mfma_f32_16x16x32_bf16 v[48:51], v[176:179], v[80:83], v[48:51]
    ds_read_b64_tr_b16 v[64:65], v42 offset:32768
    s_add_u32 m0, s71, 106496
    s_nop 0
    buffer_load_dwordx4 v32, s[28:31], s78 offen offset:0 lds
    ds_read_b64_tr_b16 v[66:67], v42 offset:33280
    v_mfma_f32_16x16x32_bf16 v[56:59], v[176:179], v[84:87], v[56:59]
    ds_read_b128 v[192:195], v38 offset:16384
    v_mfma_f32_16x16x32_bf16 v[60:63], v[180:183], v[84:87], v[60:63]
    ds_read_b64_tr_b16 v[68:69], v43 offset:32768
    ds_read_b64_tr_b16 v[70:71], v43 offset:33280
    v_mfma_f32_16x16x32_bf16 v[52:55], v[180:183], v[80:83], v[52:55]
    ds_read_b128 v[196:199], v38 offset:18432
    v_mfma_f32_16x16x32_bf16 v[48:51], v[184:187], v[88:91], v[48:51]
    ds_read_b64_tr_b16 v[72:73], v42 offset:36864
    ds_read_b64_tr_b16 v[74:75], v42 offset:37376
    v_mfma_f32_16x16x32_bf16 v[56:59], v[184:187], v[92:95], v[56:59]
    ds_read_b128 v[200:203], v39 offset:16384
    buffer_load_dwordx4 v33, s[28:31], s78 offen offset:1024 lds
    v_mfma_f32_16x16x32_bf16 v[60:63], v[188:191], v[92:95], v[60:63]
    ds_read_b64_tr_b16 v[76:77], v43 offset:36864
    ds_read_b64_tr_b16 v[78:79], v43 offset:37376
    v_mfma_f32_16x16x32_bf16 v[52:55], v[188:191], v[88:91], v[52:55]
    ds_read_b128 v[204:207], v39 offset:18432
    s_waitcnt lgkmcnt(9)
    v_mfma_f32_16x16x32_bf16 v[96:99], v[64:67], v[192:195], v[96:99]
    ds_read_b64_tr_b16 v[80:81], v40 offset:0
    s_add_u32 m0, s72, 121984
    s_nop 0
    buffer_load_dwordx4 v34, s[32:35], s85 offen offset:896 lds
    ds_read_b64_tr_b16 v[82:83], v40 offset:512
    s_waitcnt lgkmcnt(9)
    v_mfma_f32_16x16x32_bf16 v[104:107], v[68:71], v[192:195], v[104:107]
    ds_read_b64_tr_b16 v[84:85], v41 offset:0
    ds_read_b64_tr_b16 v[86:87], v41 offset:512
    s_waitcnt lgkmcnt(10)
    v_mfma_f32_16x16x32_bf16 v[108:111], v[68:71], v[196:199], v[108:111]
    ds_read_b64_tr_b16 v[88:89], v40 offset:4096
    v_mfma_f32_16x16x32_bf16 v[100:103], v[64:67], v[196:199], v[100:103]
    ds_read_b64_tr_b16 v[90:91], v40 offset:4608
    ds_read_b64_tr_b16 v[92:93], v41 offset:4096
    s_waitcnt lgkmcnt(10)
    v_mfma_f32_16x16x32_bf16 v[96:99], v[72:75], v[200:203], v[96:99]
    s_add_u32 m0, s72, 71936
    s_nop 0
    buffer_load_dwordx4 v34, s[32:35], s85 offen offset:1792 lds
    ds_read_b64_tr_b16 v[94:95], v41 offset:4608
    s_waitcnt lgkmcnt(9)
    v_mfma_f32_16x16x32_bf16 v[104:107], v[76:79], v[200:203], v[104:107]
    s_waitcnt lgkmcnt(8)
    v_mfma_f32_16x16x32_bf16 v[108:111], v[76:79], v[204:207], v[108:111]
    v_mfma_f32_16x16x32_bf16 v[100:103], v[72:75], v[204:207], v[100:103]
    s_waitcnt vmcnt(4) lgkmcnt(0)
    s_barrier
    v_mfma_f32_16x16x32_bf16 v[48:51], v[192:195], v[80:83], v[48:51]
    ds_read_b64_tr_b16 v[64:65], v40 offset:40960
    s_add_u32 m0, s71, 131072
    s_nop 0
    buffer_load_dwordx4 v32, s[28:31], s79 offen offset:0 lds
    ds_read_b64_tr_b16 v[66:67], v40 offset:41472
    v_mfma_f32_16x16x32_bf16 v[56:59], v[192:195], v[84:87], v[56:59]
    ds_read_b128 v[208:211], v36 offset:24576
    v_mfma_f32_16x16x32_bf16 v[60:63], v[196:199], v[84:87], v[60:63]
    ds_read_b64_tr_b16 v[68:69], v41 offset:40960
    ds_read_b64_tr_b16 v[70:71], v41 offset:41472
    v_mfma_f32_16x16x32_bf16 v[52:55], v[196:199], v[80:83], v[52:55]
    ds_read_b128 v[212:215], v36 offset:26624
    v_mfma_f32_16x16x32_bf16 v[48:51], v[200:203], v[88:91], v[48:51]
    ds_read_b64_tr_b16 v[72:73], v40 offset:45056
    ds_read_b64_tr_b16 v[74:75], v40 offset:45568
    v_mfma_f32_16x16x32_bf16 v[56:59], v[200:203], v[92:95], v[56:59]
    ds_read_b128 v[216:219], v37 offset:24576
    buffer_load_dwordx4 v33, s[28:31], s79 offen offset:1024 lds
    v_mfma_f32_16x16x32_bf16 v[60:63], v[204:207], v[92:95], v[60:63]
    ds_read_b64_tr_b16 v[76:77], v41 offset:45056
    ds_read_b64_tr_b16 v[78:79], v41 offset:45568
    v_mfma_f32_16x16x32_bf16 v[52:55], v[204:207], v[88:91], v[52:55]
    ds_read_b128 v[220:223], v37 offset:26624
    s_waitcnt lgkmcnt(9)
    v_mfma_f32_16x16x32_bf16 v[96:99], v[64:67], v[208:211], v[96:99]
    ds_read_b64_tr_b16 v[80:81], v40 offset:8192
    s_add_u32 m0, s72, 146560
    s_nop 0
    buffer_load_dwordx4 v34, s[32:35], s86 offen offset:896 lds
    ds_read_b64_tr_b16 v[82:83], v40 offset:8704
    s_waitcnt lgkmcnt(9)
    v_mfma_f32_16x16x32_bf16 v[104:107], v[68:71], v[208:211], v[104:107]
    ds_read_b64_tr_b16 v[84:85], v41 offset:8192
    ds_read_b64_tr_b16 v[86:87], v41 offset:8704
    s_waitcnt lgkmcnt(10)
    v_mfma_f32_16x16x32_bf16 v[108:111], v[68:71], v[212:215], v[108:111]
    ds_read_b64_tr_b16 v[88:89], v40 offset:12288
    v_mfma_f32_16x16x32_bf16 v[100:103], v[64:67], v[212:215], v[100:103]
    ds_read_b64_tr_b16 v[90:91], v40 offset:12800
    ds_read_b64_tr_b16 v[92:93], v41 offset:12288
    s_waitcnt lgkmcnt(10)
    v_mfma_f32_16x16x32_bf16 v[96:99], v[72:75], v[216:219], v[96:99]
    s_add_u32 m0, s72, 55552
    s_nop 0
    buffer_load_dwordx4 v34, s[32:35], s86 offen offset:1792 lds
    ds_read_b64_tr_b16 v[94:95], v41 offset:12800
    s_waitcnt lgkmcnt(9)
    v_mfma_f32_16x16x32_bf16 v[104:107], v[76:79], v[216:219], v[104:107]
    s_waitcnt lgkmcnt(8)
    v_mfma_f32_16x16x32_bf16 v[108:111], v[76:79], v[220:223], v[108:111]
    v_mfma_f32_16x16x32_bf16 v[100:103], v[72:75], v[220:223], v[100:103]
    s_waitcnt vmcnt(4) lgkmcnt(0)
    s_barrier
    v_mfma_f32_16x16x32_bf16 v[48:51], v[208:211], v[80:83], v[48:51]
    ds_read_b64_tr_b16 v[64:65], v42 offset:8192
    s_add_u32 m0, s72, 49152
    s_mov_b64 exec, s[8:9]
    buffer_load_dwordx4 v35, s[32:35], s80 offen offset:0 lds
    s_mov_b64 exec, -1
    ds_read_b64_tr_b16 v[66:67], v42 offset:8704
    v_mfma_f32_16x16x32_bf16 v[56:59], v[208:211], v[84:87], v[56:59]
    ds_read_b128 v[224:227], v36 offset:49152
    v_mfma_f32_16x16x32_bf16 v[60:63], v[212:215], v[84:87], v[60:63]
    ds_read_b64_tr_b16 v[68:69], v43 offset:8192
    ds_read_b64_tr_b16 v[70:71], v43 offset:8704
    v_mfma_f32_16x16x32_bf16 v[52:55], v[212:215], v[80:83], v[52:55]
    ds_read_b128 v[228:231], v36 offset:51200
    v_mfma_f32_16x16x32_bf16 v[48:51], v[216:219], v[88:91], v[48:51]
    ds_read_b64_tr_b16 v[72:73], v42 offset:12288
    s_add_u32 m0, s72, 40960
    s_mov_b64 exec, s[8:9]
    buffer_load_dwordx4 v35, s[32:35], s81 offen offset:0 lds
    s_mov_b64 exec, -1
    ds_read_b64_tr_b16 v[74:75], v42 offset:12800
    v_mfma_f32_16x16x32_bf16 v[56:59], v[216:219], v[92:95], v[56:59]
    ds_read_b128 v[232:235], v37 offset:49152
    v_mfma_f32_16x16x32_bf16 v[60:63], v[220:223], v[92:95], v[60:63]
    ds_read_b64_tr_b16 v[76:77], v43 offset:12288
    ds_read_b64_tr_b16 v[78:79], v43 offset:12800
    v_mfma_f32_16x16x32_bf16 v[52:55], v[220:223], v[88:91], v[52:55]
    ds_read_b128 v[236:239], v37 offset:51200
    s_waitcnt lgkmcnt(9)
    v_mfma_f32_16x16x32_bf16 v[96:99], v[64:67], v[224:227], v[96:99]
    ds_read_b64_tr_b16 v[80:81], v40 offset:16384
    ds_read_b64_tr_b16 v[82:83], v40 offset:16896
    s_waitcnt lgkmcnt(9)
    v_mfma_f32_16x16x32_bf16 v[104:107], v[68:71], v[224:227], v[104:107]
    ds_read_b64_tr_b16 v[84:85], v41 offset:16384
    ds_read_b64_tr_b16 v[86:87], v41 offset:16896
    s_waitcnt lgkmcnt(10)
    v_mfma_f32_16x16x32_bf16 v[108:111], v[68:71], v[228:231], v[108:111]
    ds_read_b64_tr_b16 v[88:89], v40 offset:20480
    v_mfma_f32_16x16x32_bf16 v[100:103], v[64:67], v[228:231], v[100:103]
    ds_read_b64_tr_b16 v[90:91], v40 offset:20992
    ds_read_b64_tr_b16 v[92:93], v41 offset:20480
    s_waitcnt lgkmcnt(10)
    v_mfma_f32_16x16x32_bf16 v[96:99], v[72:75], v[232:235], v[96:99]
    ds_read_b64_tr_b16 v[94:95], v41 offset:20992
    s_waitcnt lgkmcnt(9)
    v_mfma_f32_16x16x32_bf16 v[104:107], v[76:79], v[232:235], v[104:107]
    s_waitcnt lgkmcnt(8)
    v_mfma_f32_16x16x32_bf16 v[108:111], v[76:79], v[236:239], v[108:111]
    v_mfma_f32_16x16x32_bf16 v[100:103], v[72:75], v[236:239], v[100:103]
    s_waitcnt vmcnt(2) lgkmcnt(0)
    s_barrier
    v_mfma_f32_16x16x32_bf16 v[48:51], v[224:227], v[80:83], v[48:51]
    ds_read_b64_tr_b16 v[64:65], v42 offset:32768
    s_add_u32 m0, s72, 32768
    s_mov_b64 exec, s[8:9]
    buffer_load_dwordx4 v35, s[32:35], s82 offen offset:0 lds
    s_mov_b64 exec, -1
    ds_read_b64_tr_b16 v[66:67], v42 offset:33280
    v_mfma_f32_16x16x32_bf16 v[56:59], v[224:227], v[84:87], v[56:59]
    ds_read_b128 v[240:243], v38 offset:16384
    v_mfma_f32_16x16x32_bf16 v[60:63], v[228:231], v[84:87], v[60:63]
    ds_read_b64_tr_b16 v[68:69], v43 offset:32768
    ds_read_b64_tr_b16 v[70:71], v43 offset:33280
    v_mfma_f32_16x16x32_bf16 v[52:55], v[228:231], v[80:83], v[52:55]
    ds_read_b128 v[244:247], v38 offset:18432
    v_mfma_f32_16x16x32_bf16 v[48:51], v[232:235], v[88:91], v[48:51]
    ds_read_b64_tr_b16 v[72:73], v42 offset:36864
    ds_read_b64_tr_b16 v[74:75], v42 offset:37376
    v_mfma_f32_16x16x32_bf16 v[56:59], v[232:235], v[92:95], v[56:59]
    ds_read_b128 v[248:251], v39 offset:16384
    v_mfma_f32_16x16x32_bf16 v[60:63], v[236:239], v[92:95], v[60:63]
    ds_read_b64_tr_b16 v[76:77], v43 offset:36864
    ds_read_b64_tr_b16 v[78:79], v43 offset:37376
    v_mfma_f32_16x16x32_bf16 v[52:55], v[236:239], v[88:91], v[52:55]
    ds_read_b128 v[252:255], v39 offset:18432
    s_waitcnt lgkmcnt(9)
    v_mfma_f32_16x16x32_bf16 v[96:99], v[64:67], v[240:243], v[96:99]
    ds_read_b64_tr_b16 v[80:81], v40 offset:0
    ds_read_b64_tr_b16 v[82:83], v40 offset:512
    s_waitcnt lgkmcnt(9)
    v_mfma_f32_16x16x32_bf16 v[104:107], v[68:71], v[240:243], v[104:107]
    ds_read_b64_tr_b16 v[84:85], v41 offset:0
    ds_read_b64_tr_b16 v[86:87], v41 offset:512
    s_waitcnt lgkmcnt(10)
    v_mfma_f32_16x16x32_bf16 v[108:111], v[68:71], v[244:247], v[108:111]
    ds_read_b64_tr_b16 v[88:89], v40 offset:4096
    v_mfma_f32_16x16x32_bf16 v[100:103], v[64:67], v[244:247], v[100:103]
    ds_read_b64_tr_b16 v[90:91], v40 offset:4608
    ds_read_b64_tr_b16 v[92:93], v41 offset:4096
    s_waitcnt lgkmcnt(10)
    v_mfma_f32_16x16x32_bf16 v[96:99], v[72:75], v[248:251], v[96:99]
    ds_read_b64_tr_b16 v[94:95], v41 offset:4608
    s_waitcnt lgkmcnt(9)
    v_mfma_f32_16x16x32_bf16 v[104:107], v[76:79], v[248:251], v[104:107]
    s_waitcnt lgkmcnt(8)
    v_mfma_f32_16x16x32_bf16 v[108:111], v[76:79], v[252:255], v[108:111]
    v_mfma_f32_16x16x32_bf16 v[100:103], v[72:75], v[252:255], v[100:103]
    s_waitcnt lgkmcnt(6)
    v_mfma_f32_16x16x32_bf16 v[48:51], v[240:243], v[80:83], v[48:51]
    s_waitcnt lgkmcnt(4)
    v_mfma_f32_16x16x32_bf16 v[56:59], v[240:243], v[84:87], v[56:59]
    v_mfma_f32_16x16x32_bf16 v[60:63], v[244:247], v[84:87], v[60:63]
    v_mfma_f32_16x16x32_bf16 v[52:55], v[244:247], v[80:83], v[52:55]
    s_waitcnt lgkmcnt(2)
    v_mfma_f32_16x16x32_bf16 v[48:51], v[248:251], v[88:91], v[48:51]
    s_waitcnt lgkmcnt(0)
    v_mfma_f32_16x16x32_bf16 v[56:59], v[248:251], v[92:95], v[56:59]
    v_mfma_f32_16x16x32_bf16 v[60:63], v[252:255], v[92:95], v[60:63]
    v_mfma_f32_16x16x32_bf16 v[52:55], v[252:255], v[88:91], v[52:55]
    v_cvt_pk_bf16_f32 v36, v96, v97
    v_cvt_pk_bf16_f32 v37, v98, v99
    v_cvt_pk_bf16_f32 v38, v100, v101
    v_cvt_pk_bf16_f32 v39, v102, v103
    buffer_store_dwordx4 v[36:39], v46, s[36:39], 0 offen offset:0 sc1
    v_cvt_pk_bf16_f32 v40, v104, v105
    v_cvt_pk_bf16_f32 v41, v106, v107
    v_cvt_pk_bf16_f32 v42, v108, v109
    v_cvt_pk_bf16_f32 v43, v110, v111
    buffer_store_dwordx4 v[40:43], v46, s[36:39], 0 offen offset:1024 sc1
    v_cvt_pk_bf16_f32 v24, v48, v49
    v_cvt_pk_bf16_f32 v25, v50, v51
    v_cvt_pk_bf16_f32 v26, v52, v53
    v_cvt_pk_bf16_f32 v27, v54, v55
    buffer_store_dwordx4 v[24:27], v11, s[36:39], s22 offen sc1
    v_cvt_pk_bf16_f32 v28, v56, v57
    v_cvt_pk_bf16_f32 v29, v58, v59
    v_cvt_pk_bf16_f32 v30, v60, v61
    v_cvt_pk_bf16_f32 v31, v62, v63
    buffer_store_dwordx4 v[28:31], v11, s[36:39], s22 offen offset:256 sc1
    s_waitcnt vmcnt(4)
    s_barrier
    ds_read_b64_tr_b16 v[64:65], v44 offset:49152
    ds_read_b64_tr_b16 v[66:67], v44 offset:49664
    ds_read_b64_tr_b16 v[68:69], v45 offset:49152
    ds_read_b64_tr_b16 v[70:71], v45 offset:49664
    ds_read_b64_tr_b16 v[72:73], v44 offset:53248
    ds_read_b64_tr_b16 v[74:75], v44 offset:53760
    ds_read_b64_tr_b16 v[76:77], v45 offset:53248
    ds_read_b64_tr_b16 v[78:79], v45 offset:53760
    s_waitcnt lgkmcnt(6)
    v_mfma_f32_16x16x32_bf16 v[96:99], v[64:67], v[144:147], 0
    ds_read_b64_tr_b16 v[80:81], v44 offset:40960
    v_bfe_u32 v12, v0, 4, 2
    v_min_u32 v12, 2, v12
    v_add_u32 v13, s65, v12
    v_cmp_gt_u32 vcc, 2, v13
    s_waitcnt lgkmcnt(5)
    v_mfma_f32_16x16x32_bf16 v[104:107], v[68:71], v[144:147], 0
    ds_read_b64_tr_b16 v[82:83], v44 offset:41472
    v_and_b32 v13, 0xf0, v1
    v_lshl_add_u32 v12, v12, 13, v13
    s_add_u32 s87, s18, 116480
    v_add_u32 v12, s87, v12
    v_mfma_f32_16x16x32_bf16 v[108:111], v[68:71], v[148:151], 0
    ds_read_b64_tr_b16 v[84:85], v45 offset:40960
    v_mov_b32 v13, 0xf1490000
    v_mov_b32 v15, 0
    v_cndmask_b32_e64 v14, 0, v13, vcc
    v_mov_b32 v17, 0
    v_mfma_f32_16x16x32_bf16 v[100:103], v[64:67], v[148:151], 0
    ds_read_b64_tr_b16 v[86:87], v45 offset:41472
    v_mov_b32 v16, v14
    ds_write_b128 v12, v[14:17]
    v_bfe_u32 v12, v0, 4, 2
    v_min_u32 v12, 2, v12
    s_waitcnt lgkmcnt(7)
    v_mfma_f32_16x16x32_bf16 v[96:99], v[72:75], v[152:155], v[96:99]
    ds_read_b64_tr_b16 v[88:89], v44 offset:45056
    v_bfe_u32 v13, v0, 2, 2
    v_lshlrev_b32 v13, 9, v13
    v_lshl_add_u32 v12, v12, 13, v13
    v_and_b32 v13, 1, v0
    s_waitcnt lgkmcnt(6)
    v_mfma_f32_16x16x32_bf16 v[104:107], v[76:79], v[152:155], v[104:107]
    ds_read_b64_tr_b16 v[90:91], v44 offset:45568
    v_lshl_add_u32 v12, v13, 6, v12
    v_and_b32 v13, 2, v0
    v_cmp_eq_u32 vcc, 0, v13
    v_lshl_add_u32 v12, v13, 7, v12
    v_mfma_f32_16x16x32_bf16 v[108:111], v[76:79], v[156:159], v[108:111]
    ds_read_b64_tr_b16 v[92:93], v45 offset:45056
    s_add_u32 s87, s18, 57520
    v_add_u32 v12, s87, v12
    v_mov_b32 v13, 0x3f803f80
    v_cndmask_b32_e64 v14, 0, v13, vcc
    v_mfma_f32_16x16x32_bf16 v[100:103], v[72:75], v[156:159], v[100:103]
    ds_read_b64_tr_b16 v[94:95], v45 offset:45568
    v_mov_b32 v15, v14
    v_mov_b32 v16, v14
    v_mov_b32 v17, v14
    ds_write_b128 v12, v[14:17]
    s_waitcnt lgkmcnt(8)
    v_mfma_f32_16x16x32_bf16 v[96:99], v[80:83], v[160:163], v[96:99]
    s_waitcnt lgkmcnt(6)
    v_mfma_f32_16x16x32_bf16 v[104:107], v[84:87], v[160:163], v[104:107]
    v_mfma_f32_16x16x32_bf16 v[108:111], v[84:87], v[164:167], v[108:111]
    v_mfma_f32_16x16x32_bf16 v[100:103], v[80:83], v[164:167], v[100:103]
    s_waitcnt lgkmcnt(3)
    v_mfma_f32_16x16x32_bf16 v[96:99], v[88:91], v[168:171], v[96:99]
    s_waitcnt lgkmcnt(1)
    v_mfma_f32_16x16x32_bf16 v[104:107], v[92:95], v[168:171], v[104:107]
    v_mfma_f32_16x16x32_bf16 v[108:111], v[92:95], v[172:175], v[108:111]
    v_mfma_f32_16x16x32_bf16 v[100:103], v[88:91], v[172:175], v[100:103]
    s_add_u32 m0, s72, 24576
    s_mov_b64 exec, s[8:9]
    buffer_load_dwordx4 v35, s[32:35], s83 offen offset:0 lds
    s_mov_b64 exec, -1
    s_add_u32 m0, s72, 16384
    s_mov_b64 exec, s[8:9]
    buffer_load_dwordx4 v35, s[32:35], s84 offen offset:0 lds
    s_mov_b64 exec, -1
    s_waitcnt vmcnt(2)
    s_barrier
    s_cmp_eq_u32 s96, 1
    s_cbranch_scc1 L_B1
    s_setprio 1
    s_cmp_lg_u32 s66, 3
    s_cbranch_scc1 L_nw3
    s_atomic_add s26, s[36:37], s0
L_nw3:
    ds_read_b64_tr_b16 v[64:65], v44 offset:32768
    ds_read_b64_tr_b16 v[66:67], v44 offset:33280
    ds_read_b64_tr_b16 v[68:69], v45 offset:32768
    ds_read_b64_tr_b16 v[70:71], v45 offset:33280
    ds_read_b64_tr_b16 v[72:73], v44 offset:36864
    ds_read_b64_tr_b16 v[74:75], v44 offset:37376
    ds_read_b64_tr_b16 v[76:77], v45 offset:36864
    ds_read_b64_tr_b16 v[78:79], v45 offset:37376
    s_waitcnt lgkmcnt(0)
    v_mfma_f32_16x16x32_bf16 v[96:99], v[64:67], v[176:179], v[96:99]
    v_mfma_f32_16x16x32_bf16 v[104:107], v[68:71], v[176:179], v[104:107]
    v_mfma_f32_16x16x32_bf16 v[108:111], v[68:71], v[180:183], v[108:111]
    v_mfma_f32_16x16x32_bf16 v[100:103], v[64:67], v[180:183], v[100:103]
    v_mfma_f32_16x16x32_bf16 v[96:99], v[72:75], v[184:187], v[96:99]
    v_mfma_f32_16x16x32_bf16 v[104:107], v[76:79], v[184:187], v[104:107]
    v_mfma_f32_16x16x32_bf16 v[108:111], v[76:79], v[188:191], v[108:111]
    v_mfma_f32_16x16x32_bf16 v[100:103], v[72:75], v[188:191], v[100:103]
    s_add_u32 m0, s72, 8192
    s_mov_b64 exec, s[8:9]
    buffer_load_dwordx4 v35, s[32:35], s85 offen offset:0 lds
    s_mov_b64 exec, -1
    s_add_u32 m0, s72, 0
    s_mov_b64 exec, s[8:9]
    buffer_load_dwordx4 v35, s[32:35], s86 offen offset:0 lds
    s_mov_b64 exec, -1
    s_and_b32 s87, s71, 0x1fff
    s_mul_i32 s80, s73, 448
    s_lshl_b32 s73, s73, 6
    s_add_u32 s73, s73, s87
    s_mul_i32 s81, s74, 448
    s_lshl_b32 s74, s74, 6
    s_add_u32 s74, s74, s87
    s_mul_i32 s82, s75, 448
    s_lshl_b32 s75, s75, 6
    s_add_u32 s75, s75, s87
    s_mul_i32 s83, s76, 448
    s_lshl_b32 s76, s76, 6
    s_add_u32 s76, s76, s87
    s_mul_i32 s84, s77, 448
    s_lshl_b32 s77, s77, 6
    s_add_u32 s77, s77, s87
    s_mul_i32 s85, s78, 448
    s_lshl_b32 s78, s78, 6
    s_add_u32 s78, s78, s87
    s_mul_i32 s86, s79, 448
    s_lshl_b32 s79, s79, 6
    s_add_u32 s79, s79, s87
    s_load_dword s52, s[100:101], s92 glc
    s_load_dword s53, s[100:101], s94 glc
    s_waitcnt vmcnt(2)
    s_barrier
    s_mul_i32 s23, s62, 3584
    s_add_u32 s23, s23, s15
    s_add_u32 s23, s23, 0x100000
    s_cmp_eq_u32 s66, 3
    s_cbranch_scc1 L_w3
    s_waitcnt lgkmcnt(0)
    s_xor_b64 s[52:53], s[52:53], s[26:27]
    s_cbranch_scc1 L_spin_K
L_go_K:
    s_add_u32 m0, s16, 114688
    s_add_u32 s99, s23, 0
    buffer_load_dwordx4 v1, s[36:39], s99 offen offset:0 sc1 lds
    s_add_u32 m0, s16, 139264
    s_add_u32 s99, s23, 1792
    buffer_load_dwordx4 v1, s[36:39], s99 offen offset:0 sc1 lds
    s_add_u32 m0, s16, 116736
    s_add_u32 s99, s23, 28672
    buffer_load_dwordx4 v1, s[36:39], s99 offen offset:0 sc1 lds
    s_add_u32 m0, s16, 141312
    s_add_u32 s99, s23, 30464
    buffer_load_dwordx4 v1, s[36:39], s99 offen offset:0 sc1 lds
    s_add_u32 m0, s16, 118784
    s_add_u32 s99, s23, 57344
    buffer_load_dwordx4 v1, s[36:39], s99 offen offset:0 sc1 lds
    s_add_u32 m0, s16, 143360
    s_add_u32 s99, s23, 59136
    buffer_load_dwordx4 v1, s[36:39], s99 offen offset:0 sc1 lds
    s_add_u32 m0, s16, 120832
    s_add_u32 s99, s23, 86016
    buffer_load_dwordx4 v1, s[36:39], s99 offen offset:0 sc1 lds
    s_add_u32 m0, s16, 145408
    s_add_u32 s99, s23, 87808
    buffer_load_dwordx4 v1, s[36:39], s99 offen offset:0 sc1 lds
    s_mov_b64 exec, s[10:11]
    s_add_u32 m0, s16, 114688
    s_add_u32 s99, s23, 0
    buffer_load_dwordx4 v1, s[36:39], s99 offen offset:1024 sc1 lds
    s_add_u32 m0, s16, 139264
    s_add_u32 s99, s23, 1792
    buffer_load_dwordx4 v1, s[36:39], s99 offen offset:1024 sc1 lds
    s_add_u32 m0, s16, 116736
    s_add_u32 s99, s23, 28672
    buffer_load_dwordx4 v1, s[36:39], s99 offen offset:1024 sc1 lds
    s_add_u32 m0, s16, 141312
    s_add_u32 s99, s23, 30464
    buffer_load_dwordx4 v1, s[36:39], s99 offen offset:1024 sc1 lds
    s_add_u32 m0, s16, 118784
    s_add_u32 s99, s23, 57344
    buffer_load_dwordx4 v1, s[36:39], s99 offen offset:1024 sc1 lds
    s_add_u32 m0, s16, 143360
    s_add_u32 s99, s23, 59136
    buffer_load_dwordx4 v1, s[36:39], s99 offen offset:1024 sc1 lds
    s_add_u32 m0, s16, 120832
    s_add_u32 s99, s23, 86016
    buffer_load_dwordx4 v1, s[36:39], s99 offen offset:1024 sc1 lds
    s_add_u32 m0, s16, 145408
    s_add_u32 s99, s23, 87808
    buffer_load_dwordx4 v1, s[36:39], s99 offen offset:1024 sc1 lds
    s_mov_b64 exec, -1
L_w3k:
    s_waitcnt vmcnt(16)
    s_barrier
    ds_read_b64_tr_b16 v[80:81], v44 offset:24576
    ds_read_b64_tr_b16 v[82:83], v44 offset:25088
    ds_read_b64_tr_b16 v[84:85], v45 offset:24576
    ds_read_b64_tr_b16 v[86:87], v45 offset:25088
    ds_read_b64_tr_b16 v[88:89], v44 offset:28672
    ds_read_b64_tr_b16 v[90:91], v44 offset:29184
    ds_read_b64_tr_b16 v[92:93], v45 offset:28672
    ds_read_b64_tr_b16 v[94:95], v45 offset:29184
    s_waitcnt lgkmcnt(6)
    v_mfma_f32_16x16x32_bf16 v[96:99], v[80:83], v[192:195], v[96:99]
    ds_read_b64_tr_b16 v[64:65], v44 offset:16384
    s_waitcnt lgkmcnt(5)
    v_mfma_f32_16x16x32_bf16 v[104:107], v[84:87], v[192:195], v[104:107]
    ds_read_b64_tr_b16 v[66:67], v44 offset:16896
    v_mfma_f32_16x16x32_bf16 v[108:111], v[84:87], v[196:199], v[108:111]
    ds_read_b64_tr_b16 v[68:69], v45 offset:16384
    v_mfma_f32_16x16x32_bf16 v[100:103], v[80:83], v[196:199], v[100:103]
    ds_read_b64_tr_b16 v[70:71], v45 offset:16896
    s_waitcnt lgkmcnt(6)
    v_mfma_f32_16x16x32_bf16 v[96:99], v[88:91], v[200:203], v[96:99]
    ds_read_b64_tr_b16 v[72:73], v44 offset:20480
    s_waitcnt lgkmcnt(5)
    v_mfma_f32_16x16x32_bf16 v[104:107], v[92:95], v[200:203], v[104:107]
    ds_read_b64_tr_b16 v[74:75], v44 offset:20992
    v_mfma_f32_16x16x32_bf16 v[108:111], v[92:95], v[204:207], v[108:111]
    ds_read_b64_tr_b16 v[76:77], v45 offset:20480
    v_mfma_f32_16x16x32_bf16 v[100:103], v[88:91], v[204:207], v[100:103]
    ds_read_b64_tr_b16 v[78:79], v45 offset:20992
    s_waitcnt lgkmcnt(6)
    v_mfma_f32_16x16x32_bf16 v[96:99], v[64:67], v[208:211], v[96:99]
    ds_read_b64_tr_b16 v[80:81], v44 offset:8192
    s_waitcnt lgkmcnt(5)
    v_mfma_f32_16x16x32_bf16 v[104:107], v[68:71], v[208:211], v[104:107]
    ds_read_b64_tr_b16 v[82:83], v44 offset:8704
    v_mfma_f32_16x16x32_bf16 v[108:111], v[68:71], v[212:215], v[108:111]
    ds_read_b64_tr_b16 v[84:85], v45 offset:8192
    v_mfma_f32_16x16x32_bf16 v[100:103], v[64:67], v[212:215], v[100:103]
    ds_read_b64_tr_b16 v[86:87], v45 offset:8704
    s_waitcnt lgkmcnt(6)
    v_mfma_f32_16x16x32_bf16 v[96:99], v[72:75], v[216:219], v[96:99]
    ds_read_b64_tr_b16 v[88:89], v44 offset:12288
    s_waitcnt lgkmcnt(5)
    v_mfma_f32_16x16x32_bf16 v[104:107], v[76:79], v[216:219], v[104:107]
    ds_read_b64_tr_b16 v[90:91], v44 offset:12800
    v_mfma_f32_16x16x32_bf16 v[108:111], v[76:79], v[220:223], v[108:111]
    ds_read_b64_tr_b16 v[92:93], v45 offset:12288
    v_mfma_f32_16x16x32_bf16 v[100:103], v[72:75], v[220:223], v[100:103]
    ds_read_b64_tr_b16 v[94:95], v45 offset:12800
    s_waitcnt lgkmcnt(6)
    v_mfma_f32_16x16x32_bf16 v[96:99], v[80:83], v[224:227], v[96:99]
    ds_read_b64_tr_b16 v[64:65], v44 offset:0
    s_waitcnt lgkmcnt(5)
    v_mfma_f32_16x16x32_bf16 v[104:107], v[84:87], v[224:227], v[104:107]
    ds_read_b64_tr_b16 v[66:67], v44 offset:512
    v_mfma_f32_16x16x32_bf16 v[108:111], v[84:87], v[228:231], v[108:111]
    ds_read_b64_tr_b16 v[68:69], v45 offset:0
    v_mfma_f32_16x16x32_bf16 v[100:103], v[80:83], v[228:231], v[100:103]
    ds_read_b64_tr_b16 v[70:71], v45 offset:512
    s_waitcnt lgkmcnt(6)
    v_mfma_f32_16x16x32_bf16 v[96:99], v[88:91], v[232:235], v[96:99]
    ds_read_b64_tr_b16 v[72:73], v44 offset:4096
    s_waitcnt lgkmcnt(5)
    v_mfma_f32_16x16x32_bf16 v[104:107], v[92:95], v[232:235], v[104:107]
    ds_read_b64_tr_b16 v[74:75], v44 offset:4608
    v_mfma_f32_16x16x32_bf16 v[108:111], v[92:95], v[236:239], v[108:111]
    ds_read_b64_tr_b16 v[76:77], v45 offset:4096
    v_mfma_f32_16x16x32_bf16 v[100:103], v[88:91], v[236:239], v[100:103]
    ds_read_b64_tr_b16 v[78:79], v45 offset:4608
    s_waitcnt lgkmcnt(6)
    v_mfma_f32_16x16x32_bf16 v[96:99], v[64:67], v[240:243], v[96:99]
    s_waitcnt lgkmcnt(4)
    v_mfma_f32_16x16x32_bf16 v[104:107], v[68:71], v[240:243], v[104:107]
    v_mfma_f32_16x16x32_bf16 v[108:111], v[68:71], v[244:247], v[108:111]
    v_mfma_f32_16x16x32_bf16 v[100:103], v[64:67], v[244:247], v[100:103]
    s_waitcnt lgkmcnt(2)
    v_mfma_f32_16x16x32_bf16 v[96:99], v[72:75], v[248:251], v[96:99]
    s_waitcnt lgkmcnt(0)
    v_mfma_f32_16x16x32_bf16 v[104:107], v[76:79], v[248:251], v[104:107]
    v_mfma_f32_16x16x32_bf16 v[108:111], v[76:79], v[252:255], v[108:111]
    v_mfma_f32_16x16x32_bf16 v[100:103], v[72:75], v[252:255], v[100:103]
    s_nop 6
    v_mul_f32 v4, 0x3fb8aa3b, v108
    v_mul_f32 v12, 0x3fb8aa3b, v104
    s_nop 1
    v_permlane16_swap_b32 v12, v4
    v_mov_b32 v12, v4
    s_nop 1
    v_permlane32_swap_b32 v12, v4
    v_exp_f32 v4, v4
    s_nop 0
    v_add_f32 v4, 1.0, v4
    v_rcp_f32 v4, v4
    v_mul_f32 v96, 0x3e8b97f6, v96
    v_mul_f32 v97, 0x3e8b97f6, v97
    v_cvt_pk_bf16_f32 v24, v96, v97
    v_mul_f32 v98, 0x3e8b97f6, v98
    v_mul_f32 v99, 0x3e8b97f6, v99
    v_cvt_pk_bf16_f32 v25, v98, v99
    v_mul_f32 v100, 0x3e8b97f6, v100
    v_mul_f32 v101, 0x3e8b97f6, v101
    v_cvt_pk_bf16_f32 v26, v100, v101
    v_mul_f32 v102, 0x3e8b97f6, v102
    v_mul_f32 v103, 0x3e8b97f6, v103
    v_cvt_pk_bf16_f32 v27, v102, v103
    v_mul_f32 v104, 0x3e8b97f6, v104
    v_mul_f32 v105, 0x3e8b97f6, v105
    v_cvt_pk_bf16_f32 v28, v104, v105
    v_mul_f32 v106, 0x3e8b97f6, v106
    v_mul_f32 v107, 0x3e8b97f6, v107
    v_cvt_pk_bf16_f32 v29, v106, v107
    v_mul_f32 v108, 0x3e8b97f6, v108
    v_mul_f32 v109, 0x3e8b97f6, v109
    v_cvt_pk_bf16_f32 v30, v108, v109
    v_mul_f32 v110, 0x3e8b97f6, v110
    v_mul_f32 v111, 0x3e8b97f6, v111
    v_cvt_pk_bf16_f32 v31, v110, v111
    v_bfe_u32 v12, v0, 3, 1
    v_mul_u32_u24 v12, 120, v12
    v_permlane16_swap_b32 v24, v26
    v_permlane16_swap_b32 v25, v27
    v_permlane16_swap_b32 v28, v30
    v_permlane16_swap_b32 v29, v31
    v_bfe_u32 v13, v0, 4, 1
    v_cndmask_b32 v30, v30, 1.0, s[90:91]
    v_lshl_add_u32 v12, v13, 7, v12
    v_sub_u32 v12, v10, v12
    v_add_u32 v12, 57344, v12
    s_waitcnt vmcnt(0)
    s_barrier
    s_setprio 1
    ds_read_b64 v[64:65], v12 offset:0
    ds_read_b64 v[66:67], v12 offset:256
    ds_read_b64 v[68:69], v12 offset:1024
    ds_read_b64 v[70:71], v12 offset:1280
    ds_read_b64 v[72:73], v12 offset:2048
    ds_read_b64 v[74:75], v12 offset:2304
    ds_read_b64 v[76:77], v12 offset:3072
    ds_read_b64 v[78:79], v12 offset:3328
    ds_read_b64 v[80:81], v12 offset:4096
    ds_read_b64 v[82:83], v12 offset:4352
    ds_read_b64 v[84:85], v12 offset:5120
    ds_read_b64 v[86:87], v12 offset:5376
    ds_read_b64 v[88:89], v12 offset:6144
    ds_read_b64 v[90:91], v12 offset:6400
    ds_read_b64 v[92:93], v12 offset:7168
    ds_read_b64 v[94:95], v12 offset:7424
    s_waitcnt lgkmcnt(14)
    v_mfma_f32_32x32x16_bf16 v[112:127], v[64:67], v[24:27], v[112:127]
    s_waitcnt lgkmcnt(12)
    v_mfma_f32_32x32x16_bf16 v[112:127], v[68:71], v[28:31], v[112:127]
    ds_read_b64 v[64:65], v12 offset:8192
    ds_read_b64 v[66:67], v12 offset:8448
    ds_read_b64 v[68:69], v12 offset:9216
    ds_read_b64 v[70:71], v12 offset:9472
    s_waitcnt lgkmcnt(14)
    v_mfma_f32_32x32x16_bf16 v[144:159], v[72:75], v[24:27], 0
    s_waitcnt lgkmcnt(12)
    v_mfma_f32_32x32x16_bf16 v[144:159], v[76:79], v[28:31], v[144:159]
    ds_read_b64 v[72:73], v12 offset:10240
    ds_read_b64 v[74:75], v12 offset:10496
    ds_read_b64 v[76:77], v12 offset:11264
    ds_read_b64 v[78:79], v12 offset:11520
    v_exp_f32 v112, v112
    s_waitcnt lgkmcnt(14)
    v_mfma_f32_32x32x16_bf16 v[160:175], v[80:83], v[24:27], 0
    v_exp_f32 v113, v113
    s_waitcnt lgkmcnt(12)
    v_mfma_f32_32x32x16_bf16 v[160:175], v[84:87], v[28:31], v[160:175]
    v_exp_f32 v114, v114
    ds_read_b64 v[80:81], v12 offset:12288
    v_exp_f32 v115, v115
    ds_read_b64 v[82:83], v12 offset:12544
    v_cvt_pk_bf16_f32 v112, v112, v113
    ds_read_b64 v[84:85], v12 offset:13312
    v_exp_f32 v116, v116
    ds_read_b64 v[86:87], v12 offset:13568
    v_exp_f32 v117, v117
    s_waitcnt lgkmcnt(14)
    v_mfma_f32_32x32x16_bf16 v[176:191], v[88:91], v[24:27], 0
    v_cvt_pk_bf16_f32 v113, v114, v115
    s_waitcnt lgkmcnt(12)
    v_mfma_f32_32x32x16_bf16 v[176:191], v[92:95], v[28:31], v[176:191]
    v_exp_f32 v118, v118
    v_exp_f32 v119, v119
    ds_read_b64 v[88:89], v12 offset:14336
    v_cvt_pk_bf16_f32 v114, v116, v117
    ds_read_b64 v[90:91], v12 offset:14592
    v_exp_f32 v120, v120
    ds_read_b64 v[92:93], v12 offset:15360
    ds_read_b64 v[94:95], v12 offset:15616
    v_exp_f32 v121, v121
    s_waitcnt lgkmcnt(14)
    v_mfma_f32_32x32x16_bf16 v[192:207], v[64:67], v[24:27], 0
    v_cvt_pk_bf16_f32 v115, v118, v119
    v_exp_f32 v122, v122
    s_waitcnt lgkmcnt(12)
    v_mfma_f32_32x32x16_bf16 v[192:207], v[68:71], v[28:31], v[192:207]
    v_exp_f32 v123, v123
    ds_read_b64 v[64:65], v12 offset:16384
    v_cvt_pk_bf16_f32 v116, v120, v121
    v_exp_f32 v124, v124
    ds_read_b64 v[66:67], v12 offset:16640
    ds_read_b64 v[68:69], v12 offset:17408
    v_exp_f32 v125, v125
    ds_read_b64 v[70:71], v12 offset:17664
    v_cvt_pk_bf16_f32 v117, v122, v123
    s_waitcnt lgkmcnt(14)
    v_mfma_f32_32x32x16_bf16 v[208:223], v[72:75], v[24:27], 0
    v_exp_f32 v126, v126
    v_exp_f32 v127, v127
    s_waitcnt lgkmcnt(12)
    v_mfma_f32_32x32x16_bf16 v[208:223], v[76:79], v[28:31], v[208:223]
    v_cvt_pk_bf16_f32 v118, v124, v125
    v_cvt_pk_bf16_f32 v119, v126, v127
    v_exp_f32 v144, v144
    s_waitcnt lgkmcnt(10)
    v_mfma_f32_32x32x16_bf16 v[224:239], v[80:83], v[24:27], 0
    v_exp_f32 v145, v145
    v_exp_f32 v146, v146
    v_exp_f32 v147, v147
    s_waitcnt lgkmcnt(8)
    v_mfma_f32_32x32x16_bf16 v[224:239], v[84:87], v[28:31], v[224:239]
    v_cvt_pk_bf16_f32 v144, v144, v145
    v_exp_f32 v148, v148
    v_exp_f32 v149, v149
    v_cvt_pk_bf16_f32 v145, v146, v147
    s_waitcnt lgkmcnt(6)
    v_mfma_f32_32x32x16_bf16 v[240:255], v[88:91], v[24:27], 0
    v_exp_f32 v150, v150
    v_exp_f32 v151, v151
    v_cvt_pk_bf16_f32 v146, v148, v149
    v_exp_f32 v152, v152
    s_waitcnt lgkmcnt(4)
    v_mfma_f32_32x32x16_bf16 v[240:255], v[92:95], v[28:31], v[240:255]
    v_exp_f32 v153, v153
    v_cvt_pk_bf16_f32 v147, v150, v151
    v_exp_f32 v154, v154
    v_exp_f32 v155, v155
    s_waitcnt lgkmcnt(2)
    v_mfma_f32_32x32x16_bf16 v[128:143], v[64:67], v[24:27], v[128:143]
    v_cvt_pk_bf16_f32 v148, v152, v153
    v_exp_f32 v156, v156
    v_exp_f32 v157, v157
    s_waitcnt lgkmcnt(0)
    v_mfma_f32_32x32x16_bf16 v[128:143], v[68:71], v[28:31], v[128:143]
    v_cvt_pk_bf16_f32 v149, v154, v155
    v_exp_f32 v158, v158
    v_exp_f32 v159, v159
    v_cvt_pk_bf16_f32 v150, v156, v157
    v_cvt_pk_bf16_f32 v151, v158, v159
    v_exp_f32 v160, v160
    v_exp_f32 v161, v161
    v_exp_f32 v162, v162
    v_exp_f32 v163, v163
    v_cvt_pk_bf16_f32 v160, v160, v161
    v_exp_f32 v164, v164
    v_exp_f32 v165, v165
    v_cvt_pk_bf16_f32 v161, v162, v163
    v_exp_f32 v166, v166
    v_exp_f32 v167, v167
    v_cvt_pk_bf16_f32 v162, v164, v165
    v_exp_f32 v168, v168
    v_exp_f32 v169, v169
    v_cvt_pk_bf16_f32 v163, v166, v167
    v_exp_f32 v170, v170
    v_exp_f32 v171, v171
    v_cvt_pk_bf16_f32 v164, v168, v169
    v_exp_f32 v172, v172
    v_exp_f32 v173, v173
    v_cvt_pk_bf16_f32 v165, v170, v171
    v_exp_f32 v174, v174
    v_exp_f32 v175, v175
    v_cvt_pk_bf16_f32 v166, v172, v173
    v_cvt_pk_bf16_f32 v167, v174, v175
    v_exp_f32 v176, v176
    v_exp_f32 v177, v177
    v_exp_f32 v178, v178
    v_exp_f32 v179, v179
    v_cvt_pk_bf16_f32 v176, v176, v177
    v_exp_f32 v180, v180
    v_exp_f32 v181, v181
    v_cvt_pk_bf16_f32 v177, v178, v179
    v_exp_f32 v182, v182
    v_exp_f32 v183, v183
    v_cvt_pk_bf16_f32 v178, v180, v181
    v_exp_f32 v184, v184
    v_exp_f32 v185, v185
    v_cvt_pk_bf16_f32 v179, v182, v183
    v_exp_f32 v186, v186
    v_exp_f32 v187, v187
    v_cvt_pk_bf16_f32 v180, v184, v185
    v_exp_f32 v188, v188
    v_exp_f32 v189, v189
    v_cvt_pk_bf16_f32 v181, v186, v187
    v_exp_f32 v190, v190
    v_exp_f32 v191, v191
    v_cvt_pk_bf16_f32 v182, v188, v189
    v_cvt_pk_bf16_f32 v183, v190, v191
    v_exp_f32 v192, v192
    v_exp_f32 v193, v193
    v_exp_f32 v194, v194
    v_exp_f32 v195, v195
    v_cvt_pk_bf16_f32 v192, v192, v193
    v_exp_f32 v196, v196
    v_exp_f32 v197, v197
    v_cvt_pk_bf16_f32 v193, v194, v195
    v_exp_f32 v198, v198
    v_exp_f32 v199, v199
    v_cvt_pk_bf16_f32 v194, v196, v197
    v_exp_f32 v200, v200
    v_exp_f32 v201, v201
    v_cvt_pk_bf16_f32 v195, v198, v199
    v_exp_f32 v202, v202
    v_exp_f32 v203, v203
    v_cvt_pk_bf16_f32 v196, v200, v201
    v_exp_f32 v204, v204
    v_exp_f32 v205, v205
    v_cvt_pk_bf16_f32 v197, v202, v203
    v_exp_f32 v206, v206
    v_exp_f32 v207, v207
    v_cvt_pk_bf16_f32 v198, v204, v205
    v_cvt_pk_bf16_f32 v199, v206, v207
    s_barrier
    ds_read_b128 v[64:67], v10 offset:0
    ds_read_b128 v[68:71], v10 offset:1024
    ds_read_b128 v[72:75], v10 offset:2048
    ds_read_b128 v[76:79], v10 offset:3072
    ds_read_b128 v[80:83], v10 offset:4096
    ds_read_b128 v[84:87], v10 offset:5120
    ds_read_b128 v[88:91], v10 offset:6144
    ds_read_b128 v[92:95], v10 offset:7168
    v_exp_f32 v208, v208
    s_waitcnt lgkmcnt(7)
    v_mfma_f32_32x32x16_bf16 v[48:63], v[64:67], v[112:115], 0
    v_exp_f32 v209, v209
    v_exp_f32 v210, v210
    s_waitcnt lgkmcnt(6)
    v_mfma_f32_32x32x16_bf16 v[48:63], v[68:71], v[116:119], v[48:63]
    v_exp_f32 v211, v211
    v_cvt_pk_bf16_f32 v208, v208, v209
    ds_read_b128 v[64:67], v10 offset:8192
    v_exp_f32 v212, v212
    ds_read_b128 v[68:71], v10 offset:9216
    v_exp_f32 v213, v213
    v_cvt_pk_bf16_f32 v209, v210, v211
    s_waitcnt lgkmcnt(7)
    v_mfma_f32_32x32x16_bf16 v[48:63], v[72:75], v[144:147], v[48:63]
    v_exp_f32 v214, v214
    v_exp_f32 v215, v215
    s_waitcnt lgkmcnt(6)
    v_mfma_f32_32x32x16_bf16 v[48:63], v[76:79], v[148:151], v[48:63]
    v_cvt_pk_bf16_f32 v210, v212, v213
    v_exp_f32 v216, v216
    v_exp_f32 v217, v217
    ds_read_b128 v[72:75], v10 offset:10240
    v_cvt_pk_bf16_f32 v211, v214, v215
    ds_read_b128 v[76:79], v10 offset:11264
    v_exp_f32 v218, v218
    v_exp_f32 v219, v219
    s_waitcnt lgkmcnt(7)
    v_mfma_f32_32x32x16_bf16 v[48:63], v[80:83], v[160:163], v[48:63]
    v_cvt_pk_bf16_f32 v212, v216, v217
    v_exp_f32 v220, v220
    s_waitcnt lgkmcnt(6)
    v_mfma_f32_32x32x16_bf16 v[48:63], v[84:87], v[164:167], v[48:63]
    v_exp_f32 v221, v221
    v_cvt_pk_bf16_f32 v213, v218, v219
    v_exp_f32 v222, v222
    ds_read_b128 v[80:83], v10 offset:12288
    v_exp_f32 v223, v223
    ds_read_b128 v[84:87], v10 offset:13312
    v_cvt_pk_bf16_f32 v214, v220, v221
    v_cvt_pk_bf16_f32 v215, v222, v223
    v_exp_f32 v224, v224
    s_waitcnt lgkmcnt(7)
    v_mfma_f32_32x32x16_bf16 v[48:63], v[88:91], v[176:179], v[48:63]
    v_exp_f32 v225, v225
    v_exp_f32 v226, v226
    s_waitcnt lgkmcnt(6)
    v_mfma_f32_32x32x16_bf16 v[48:63], v[92:95], v[180:183], v[48:63]
    v_exp_f32 v227, v227
    v_cvt_pk_bf16_f32 v224, v224, v225
    v_exp_f32 v228, v228
    ds_read_b128 v[88:91], v10 offset:14336
    v_exp_f32 v229, v229
    ds_read_b128 v[92:95], v10 offset:15360
    v_cvt_pk_bf16_f32 v225, v226, v227
    v_exp_f32 v230, v230
    s_waitcnt lgkmcnt(7)
    v_mfma_f32_32x32x16_bf16 v[48:63], v[64:67], v[192:195], v[48:63]
    v_exp_f32 v231, v231
    v_cvt_pk_bf16_f32 v226, v228, v229
    v_exp_f32 v232, v232
    s_waitcnt lgkmcnt(6)
    v_mfma_f32_32x32x16_bf16 v[48:63], v[68:71], v[196:199], v[48:63]
    v_exp_f32 v233, v233
    v_cvt_pk_bf16_f32 v227, v230, v231
    v_exp_f32 v234, v234
    ds_read_b128 v[64:67], v10 offset:16384
    v_exp_f32 v235, v235
    ds_read_b128 v[68:71], v10 offset:17408
    v_cvt_pk_bf16_f32 v228, v232, v233
    v_exp_f32 v236, v236
    s_waitcnt lgkmcnt(7)
    v_mfma_f32_32x32x16_bf16 v[48:63], v[72:75], v[208:211], v[48:63]
    v_exp_f32 v237, v237
    v_cvt_pk_bf16_f32 v229, v234, v235
    v_exp_f32 v238, v238
    s_waitcnt lgkmcnt(6)
    v_mfma_f32_32x32x16_bf16 v[48:63], v[76:79], v[212:215], v[48:63]
    v_exp_f32 v239, v239
    v_cvt_pk_bf16_f32 v230, v236, v237
    v_cvt_pk_bf16_f32 v231, v238, v239
    v_exp_f32 v240, v240
    s_waitcnt lgkmcnt(5)
    v_mfma_f32_32x32x16_bf16 v[48:63], v[80:83], v[224:227], v[48:63]
    v_exp_f32 v241, v241
    v_exp_f32 v242, v242
    v_exp_f32 v243, v243
    v_cvt_pk_bf16_f32 v240, v240, v241
    v_exp_f32 v244, v244
    v_exp_f32 v245, v245
    v_cvt_pk_bf16_f32 v241, v242, v243
    v_exp_f32 v246, v246
    v_exp_f32 v247, v247
    v_cvt_pk_bf16_f32 v242, v244, v245
    v_exp_f32 v248, v248
    s_waitcnt lgkmcnt(4)
    v_mfma_f32_32x32x16_bf16 v[48:63], v[84:87], v[228:231], v[48:63]
    v_exp_f32 v249, v249
    v_cvt_pk_bf16_f32 v243, v246, v247
    v_exp_f32 v250, v250
    v_exp_f32 v251, v251
    v_cvt_pk_bf16_f32 v244, v248, v249
    v_exp_f32 v252, v252
    v_exp_f32 v253, v253
    v_cvt_pk_bf16_f32 v245, v250, v251
    v_exp_f32 v254, v254
    v_exp_f32 v255, v255
    v_cvt_pk_bf16_f32 v246, v252, v253
    v_cvt_pk_bf16_f32 v247, v254, v255
    v_exp_f32 v128, v128
    s_waitcnt lgkmcnt(3)
    v_mfma_f32_32x32x16_bf16 v[48:63], v[88:91], v[240:243], v[48:63]
    v_exp_f32 v129, v129
    v_exp_f32 v130, v130
    v_exp_f32 v131, v131
    v_cvt_pk_bf16_f32 v128, v128, v129
    v_exp_f32 v132, v132
    v_exp_f32 v133, v133
    v_cvt_pk_bf16_f32 v129, v130, v131
    v_exp_f32 v134, v134
    v_exp_f32 v135, v135
    v_cvt_pk_bf16_f32 v130, v132, v133
    v_exp_f32 v136, v136
    s_waitcnt lgkmcnt(2)
    v_mfma_f32_32x32x16_bf16 v[48:63], v[92:95], v[244:247], v[48:63]
    v_exp_f32 v137, v137
    v_cvt_pk_bf16_f32 v131, v134, v135
    v_exp_f32 v138, v138
    v_exp_f32 v139, v139
    v_cvt_pk_bf16_f32 v132, v136, v137
    v_exp_f32 v140, v140
    v_exp_f32 v141, v141
    v_cvt_pk_bf16_f32 v133, v138, v139
    v_exp_f32 v142, v142
    v_exp_f32 v143, v143
    v_cvt_pk_bf16_f32 v134, v140, v141
    v_cvt_pk_bf16_f32 v135, v142, v143
    s_waitcnt lgkmcnt(1)
    v_mfma_f32_32x32x16_bf16 v[48:63], v[64:67], v[128:131], v[48:63]
    s_waitcnt lgkmcnt(0)
    v_mfma_f32_32x32x16_bf16 v[48:63], v[68:71], v[132:135], v[48:63]
    s_nop 11
    v_subrev_u32 v12, 0x2b800000, v55
    v_cmp_le_u32 vcc, 0x28000000, v12
    s_cbranch_vccnz L_attx
L_attr0:
    v_rcp_f32 v12, v55
    s_nop 0
    v_mul_f32 v12, v12, v4
    v_mul_f32 v48, v48, v12
    v_mul_f32 v49, v49, v12
    v_cvt_pk_bf16_f32 v24, v48, v49
    v_mul_f32 v50, v50, v12
    v_mul_f32 v51, v51, v12
    v_cvt_pk_bf16_f32 v25, v50, v51
    v_mul_f32 v52, v52, v12
    v_mul_f32 v53, v53, v12
    v_cvt_pk_bf16_f32 v26, v52, v53
    v_mul_f32 v54, v54, v12
    v_cvt_pk_bf16_f32 v27, v54, 0
    v_or_b32 v27, s58, v27
    buffer_store_dwordx4 v[24:27], v5, s[36:39], 0 offen offset:0 sc1
    v_mul_f32 v56, v56, v12
    v_mul_f32 v57, v57, v12
    v_cvt_pk_bf16_f32 v28, v56, v57
    v_mul_f32 v58, v58, v12
    v_mul_f32 v59, v59, v12
    v_cvt_pk_bf16_f32 v29, v58, v59
    v_mul_f32 v60, v60, v12
    v_mul_f32 v61, v61, v12
    v_cvt_pk_bf16_f32 v30, v60, v61
    v_mul_f32 v62, v62, v12
    v_cvt_pk_bf16_f32 v31, v62, 0
    v_or_b32 v31, s58, v31
    buffer_store_dwordx4 v[28:31], v5, s[36:39], 0 offen offset:1024 sc1
    v_mov_b32 v20, s1
    v_mov_b32 v21, s26
    s_mov_b64 exec, 1
    buffer_store_dword v21, v20, s[36:39], 0 offen sc1
    s_mov_b64 exec, -1
    s_setprio 0
    s_add_u32 m0, s78, 106496
    s_nop 0
    buffer_load_dwordx4 v2, s[44:47], s85 offen lds
    buffer_load_dwordx4 v3, s[44:47], s85 offen offset:1024 lds
    s_add_u32 m0, s79, 106496
    s_nop 0
    buffer_load_dwordx4 v2, s[44:47], s86 offen lds
    buffer_load_dwordx4 v3, s[44:47], s86 offen offset:1024 lds
    s_load_dwordx4 s[28:31], s[56:57], s64 glc
    s_load_dwordx4 s[32:35], s[56:57], s70 glc
    s_mov_b32 s74, 1
    s_mov_b32 s93, 0
    s_waitcnt vmcnt(0) lgkmcnt(0)
    v_mov_b32 v36, 65968
    v_mov_b32 v37, 1
    s_mov_b64 exec, 1
    ds_add_u32 v36, v37
    s_mov_b64 exec, -1
    s_branch L_p3_chk
L_p3_poll:
    s_load_dwordx4 s[28:31], s[56:57], s64 glc
    s_load_dwordx4 s[32:35], s[56:57], s70 glc
    s_add_u32 s93, s93, 1
    s_waitcnt lgkmcnt(0)
L_p3_chk:
    s_xor_b64 s[32:33], s[32:33], s[26:27]
    s_xor_b64 s[34:35], s[34:35], s[26:27]
    s_or_b64 s[32:33], s[32:33], s[34:35]
    s_cselect_b32 s80, 1, 0
    s_xor_b64 s[28:29], s[28:29], s[26:27]
    s_xor_b64 s[30:31], s[30:31], s[26:27]
    s_or_b64 s[28:29], s[28:29], s[30:31]
    s_cbranch_scc0 L_p3_go
    s_cmp_gt_u32 s93, 100000
    s_cselect_b32 s80, 0, s80
    s_cmp_eq_u32 s80, 1
    s_cbranch_scc1 L_p3_poll
    s_xor_b32 s19, s19, 1
    s_mov_b32 s70, s64
    s_mov_b32 s80, 1
L_p3_go:
    s_lshl_b32 s87, s19, 21
    s_xor_b32 s88, s87, 0x200000
    s_add_u32 s22, s20, s87
    s_add_u32 s23, s20, s88
    v_and_b32 v53, 0x300, v1
    v_add_u32 v53, v53, v1
    s_add_u32 s99, s22, 0
    buffer_load_dwordx4 v[128:131], v53, s[36:39], s99 offen offset:0 sc1
    buffer_load_dwordx4 v[132:135], v53, s[36:39], s99 offen offset:256 sc1
    buffer_load_dwordx4 v[136:139], v53, s[36:39], s99 offen offset:2048 sc1
    buffer_load_dwordx4 v[140:143], v53, s[36:39], s99 offen offset:2304 sc1
    s_add_u32 s99, s22, 4096
    buffer_load_dwordx4 v[144:147], v53, s[36:39], s99 offen offset:0 sc1
    buffer_load_dwordx4 v[148:151], v53, s[36:39], s99 offen offset:256 sc1
    buffer_load_dwordx4 v[152:155], v53, s[36:39], s99 offen offset:2048 sc1
    buffer_load_dwordx4 v[156:159], v53, s[36:39], s99 offen offset:2304 sc1
    s_cmp_eq_u32 s19, 0
    s_cselect_b32 s87, s24, 106496
    s_cselect_b32 s88, 106496, s24
    v_add_u32 v56, s87, v6
    v_xor_b32 v57, 32, v56
    v_xor_b32 v58, 64, v56
    v_xor_b32 v59, 96, v56
    v_add_u32 v60, s87, v7
    v_xor_b32 v61, 32, v60
    v_xor_b32 v62, 64, v60
    v_xor_b32 v63, 96, v60
    v_add_u32 v24, s88, v6
    v_xor_b32 v25, 32, v24
    v_xor_b32 v26, 64, v24
    v_xor_b32 v27, 96, v24
    v_add_u32 v28, s88, v7
    v_xor_b32 v29, 32, v28
    v_xor_b32 v30, 64, v28
    v_xor_b32 v31, 96, v28
    s_cmp_eq_u32 s80, 0
    s_cbranch_scc1 L_p3_early
    s_load_dwordx4 s[32:35], s[56:57], s70 glc
    s_waitcnt lgkmcnt(0)
    s_xor_b64 s[32:33], s[32:33], s[26:27]
    s_xor_b64 s[34:35], s[34:35], s[26:27]
    s_or_b64 s[32:33], s[32:33], s[34:35]
    s_cbranch_scc1 L_p3_late
L_p3_early:
    s_cmp_eq_u32 s74, 1
    s_cbranch_scc1 L_p3_both
    s_cmp_eq_u32 s74, 0
    s_cbranch_scc1 L_p3_nx2
    s_mov_b32 s93, 0
L_cwe:
    ds_read_b32 v37, v36
    s_add_u32 s93, s93, 1
    s_cmp_gt_u32 s93, 100000
    s_waitcnt lgkmcnt(0)
    v_cmp_gt_u32 vcc, 8, v37
    s_cbranch_scc1 L_cwe_ok
    s_cbranch_vccnz L_cwe
L_cwe_ok:
L_p3_nx2:
    s_waitcnt lgkmcnt(0)
    ds_read_b64_tr_b16 v[96:97], v56 offset:0
    ds_read_b64_tr_b16 v[98:99], v60 offset:1024
    ds_read_b64_tr_b16 v[100:101], v57 offset:0
    ds_read_b64_tr_b16 v[102:103], v61 offset:1024
    ds_read_b64_tr_b16 v[104:105], v58 offset:0
    ds_read_b64_tr_b16 v[106:107], v62 offset:1024
    ds_read_b64_tr_b16 v[108:109], v59 offset:0
    ds_read_b64_tr_b16 v[110:111], v63 offset:1024
    ds_read_b64_tr_b16 v[112:113], v58 offset:3584
    ds_read_b64_tr_b16 v[114:115], v62 offset:4608
    ds_read_b64_tr_b16 v[116:117], v59 offset:3584
    ds_read_b64_tr_b16 v[118:119], v63 offset:4608
    ds_read_b64_tr_b16 v[120:121], v56 offset:3584
    ds_read_b64_tr_b16 v[122:123], v60 offset:4608
    ds_read_b64_tr_b16 v[124:125], v57 offset:3584
    ds_read_b64_tr_b16 v[126:127], v61 offset:4608
L_oc0:
    s_waitcnt vmcnt(4)
    v_xor_b32 v143, s58, v143
    v_xor_b32 v139, s58, v139
    v_xor_b32 v135, s58, v135
    v_xor_b32 v131, s58, v131
    v_or3_b32 v52, v143, v139, v135
    v_or_b32 v52, v52, v131
    v_cmp_lt_u32 vcc, 0xffff, v52
    s_cbranch_vccnz L_oc0_r
L_oc0_ok:
    s_add_u32 s99, s23, 0
    buffer_load_dwordx4 v[160:163], v53, s[36:39], s99 offen offset:0 sc1
    s_waitcnt lgkmcnt(12)
    v_mfma_f32_16x16x32_bf16 v[64:67], v[96:99], v[128:131], 0
    ds_read_b64_tr_b16 v[192:193], v56 offset:7168
    v_mfma_f32_16x16x32_bf16 v[68:71], v[96:99], v[132:135], 0
    ds_read_b64_tr_b16 v[194:195], v60 offset:8192
    v_mfma_f32_16x16x32_bf16 v[76:79], v[100:103], v[132:135], 0
    ds_read_b64_tr_b16 v[196:197], v57 offset:7168
    v_mfma_f32_16x16x32_bf16 v[72:75], v[100:103], v[128:131], 0
    buffer_load_dwordx4 v[164:167], v53, s[36:39], s99 offen offset:256 sc1
    ds_read_b64_tr_b16 v[198:199], v61 offset:8192
    s_waitcnt lgkmcnt(12)
    v_mfma_f32_16x16x32_bf16 v[80:83], v[104:107], v[128:131], 0
    ds_read_b64_tr_b16 v[200:201], v58 offset:7168
    v_mfma_f32_16x16x32_bf16 v[84:87], v[104:107], v[132:135], 0
    ds_read_b64_tr_b16 v[202:203], v62 offset:8192
    v_mfma_f32_16x16x32_bf16 v[92:95], v[108:111], v[132:135], 0
    buffer_load_dwordx4 v[168:171], v53, s[36:39], s99 offen offset:2048 sc1
    ds_read_b64_tr_b16 v[204:205], v59 offset:7168
    v_mfma_f32_16x16x32_bf16 v[88:91], v[108:111], v[128:131], 0
    ds_read_b64_tr_b16 v[206:207], v63 offset:8192
    s_waitcnt lgkmcnt(12)
    v_mfma_f32_16x16x32_bf16 v[64:67], v[112:115], v[136:139], v[64:67]
    ds_read_b64_tr_b16 v[96:97], v58 offset:10752
    v_mfma_f32_16x16x32_bf16 v[68:71], v[112:115], v[140:143], v[68:71]
    buffer_load_dwordx4 v[172:175], v53, s[36:39], s99 offen offset:2304 sc1
    ds_read_b64_tr_b16 v[98:99], v62 offset:11776
    v_mfma_f32_16x16x32_bf16 v[76:79], v[116:119], v[140:143], v[76:79]
    ds_read_b64_tr_b16 v[100:101], v59 offset:10752
    v_mfma_f32_16x16x32_bf16 v[72:75], v[116:119], v[136:139], v[72:75]
    ds_read_b64_tr_b16 v[102:103], v63 offset:11776
    s_waitcnt lgkmcnt(12)
    v_mfma_f32_16x16x32_bf16 v[80:83], v[120:123], v[136:139], v[80:83]
    s_add_u32 s99, s23, 4096
    buffer_load_dwordx4 v[176:179], v53, s[36:39], s99 offen offset:0 sc1
    ds_read_b64_tr_b16 v[104:105], v56 offset:10752
    v_mfma_f32_16x16x32_bf16 v[84:87], v[120:123], v[140:143], v[84:87]
    ds_read_b64_tr_b16 v[106:107], v60 offset:11776
    v_mfma_f32_16x16x32_bf16 v[92:95], v[124:127], v[140:143], v[92:95]
    ds_read_b64_tr_b16 v[108:109], v57 offset:10752
L_oc2:
    s_waitcnt vmcnt(5)
    v_xor_b32 v159, s58, v159
    v_xor_b32 v155, s58, v155
    v_xor_b32 v151, s58, v151
    v_xor_b32 v147, s58, v147
    v_or3_b32 v52, v159, v155, v151
    v_or_b32 v52, v52, v147
    v_cmp_lt_u32 vcc, 0xffff, v52
    s_cbranch_vccnz L_oc2_r
L_oc2_ok:
    v_mfma_f32_16x16x32_bf16 v[88:91], v[124:127], v[136:139], v[88:91]
    buffer_load_dwordx4 v[180:183], v53, s[36:39], s99 offen offset:256 sc1
    ds_read_b64_tr_b16 v[110:111], v61 offset:11776
    s_waitcnt lgkmcnt(12)
    v_mfma_f32_16x16x32_bf16 v[64:67], v[192:195], v[144:147], v[64:67]
    ds_read_b64_tr_b16 v[112:113], v27 offset:0
    v_mfma_f32_16x16x32_bf16 v[68:71], v[192:195], v[148:151], v[68:71]
    ds_read_b64_tr_b16 v[114:115], v31 offset:1024
    v_mfma_f32_16x16x32_bf16 v[76:79], v[196:199], v[148:151], v[76:79]
    buffer_load_dwordx4 v[184:187], v53, s[36:39], s99 offen offset:2048 sc1
    ds_read_b64_tr_b16 v[116:117], v25 offset:3584
    v_mfma_f32_16x16x32_bf16 v[72:75], v[196:199], v[144:147], v[72:75]
    ds_read_b64_tr_b16 v[118:119], v29 offset:4608
    s_waitcnt lgkmcnt(12)
    v_mfma_f32_16x16x32_bf16 v[80:83], v[200:203], v[144:147], v[80:83]
    ds_read_b64_tr_b16 v[120:121], v27 offset:7168
    v_mfma_f32_16x16x32_bf16 v[84:87], v[200:203], v[148:151], v[84:87]
    buffer_load_dwordx4 v[188:191], v53, s[36:39], s99 offen offset:2304 sc1
    ds_read_b64_tr_b16 v[122:123], v31 offset:8192
    v_mfma_f32_16x16x32_bf16 v[92:95], v[204:207], v[148:151], v[92:95]
    ds_read_b64_tr_b16 v[124:125], v25 offset:10752
    v_mfma_f32_16x16x32_bf16 v[88:91], v[204:207], v[144:147], v[88:91]
    ds_read_b64_tr_b16 v[126:127], v29 offset:11776
    s_waitcnt lgkmcnt(12)
    v_mfma_f32_16x16x32_bf16 v[64:67], v[96:99], v[152:155], v[64:67]
    ds_read_b64_tr_b16 v[192:193], v26 offset:0
    v_mfma_f32_16x16x32_bf16 v[68:71], v[96:99], v[156:159], v[68:71]
    ds_read_b64_tr_b16 v[194:195], v30 offset:1024
    v_mfma_f32_16x16x32_bf16 v[76:79], v[100:103], v[156:159], v[76:79]
    ds_read_b64_tr_b16 v[196:197], v24 offset:3584
    v_mfma_f32_16x16x32_bf16 v[72:75], v[100:103], v[152:155], v[72:75]
    ds_read_b64_tr_b16 v[198:199], v28 offset:4608
    s_waitcnt lgkmcnt(12)
    v_mfma_f32_16x16x32_bf16 v[80:83], v[104:107], v[152:155], v[80:83]
    ds_read_b64_tr_b16 v[200:201], v26 offset:7168
    v_mfma_f32_16x16x32_bf16 v[84:87], v[104:107], v[156:159], v[84:87]
    ds_read_b64_tr_b16 v[202:203], v30 offset:8192
    v_mfma_f32_16x16x32_bf16 v[92:95], v[108:111], v[156:159], v[92:95]
    ds_read_b64_tr_b16 v[204:205], v24 offset:10752
    v_mfma_f32_16x16x32_bf16 v[88:91], v[108:111], v[152:155], v[88:91]
    ds_read_b64_tr_b16 v[206:207], v28 offset:11776
L_p3_join:
L_oc4:
    s_waitcnt vmcnt(4)
    v_xor_b32 v175, s58, v175
    v_xor_b32 v171, s58, v171
    v_xor_b32 v167, s58, v167
    v_xor_b32 v163, s58, v163
    v_or3_b32 v52, v175, v171, v167
    v_or_b32 v52, v52, v163
    v_cmp_lt_u32 vcc, 0xffff, v52
    s_cbranch_vccnz L_oc4_r
L_oc4_ok:
    s_waitcnt lgkmcnt(12)
    v_mfma_f32_16x16x32_bf16 v[88:91], v[112:115], v[160:163], v[88:91]
    ds_read_b64_tr_b16 v[96:97], v25 offset:0
    v_mfma_f32_16x16x32_bf16 v[92:95], v[112:115], v[164:167], v[92:95]
    ds_read_b64_tr_b16 v[98:99], v29 offset:1024
    v_mfma_f32_16x16x32_bf16 v[88:91], v[116:119], v[168:171], v[88:91]
    ds_read_b64_tr_b16 v[100:101], v27 offset:3584
L_oc6:
    s_waitcnt vmcnt(0)
    v_xor_b32 v191, s58, v191
    v_xor_b32 v187, s58, v187
    v_xor_b32 v183, s58, v183
    v_xor_b32 v179, s58, v179
    v_or3_b32 v52, v191, v187, v183
    v_or_b32 v52, v52, v179
    v_cmp_lt_u32 vcc, 0xffff, v52
    s_cbranch_vccnz L_oc6_r
L_oc6_ok:
    v_mfma_f32_16x16x32_bf16 v[92:95], v[116:119], v[172:175], v[92:95]
    ds_read_b64_tr_b16 v[102:103], v31 offset:4608
    s_waitcnt lgkmcnt(12)
    v_mfma_f32_16x16x32_bf16 v[88:91], v[120:123], v[176:179], v[88:91]
    ds_read_b64_tr_b16 v[104:105], v25 offset:7168
    v_mfma_f32_16x16x32_bf16 v[92:95], v[120:123], v[180:183], v[92:95]
    ds_read_b64_tr_b16 v[106:107], v29 offset:8192
    v_mfma_f32_16x16x32_bf16 v[88:91], v[124:127], v[184:187], v[88:91]
    ds_read_b64_tr_b16 v[108:109], v27 offset:10752
    v_mfma_f32_16x16x32_bf16 v[92:95], v[124:127], v[188:191], v[92:95]
    ds_read_b64_tr_b16 v[110:111], v31 offset:11776
    s_waitcnt lgkmcnt(12)
    v_mfma_f32_16x16x32_bf16 v[80:83], v[192:195], v[160:163], v[80:83]
    ds_read_b64_tr_b16 v[112:113], v24 offset:0
    v_mfma_f32_16x16x32_bf16 v[84:87], v[192:195], v[164:167], v[84:87]
    ds_read_b64_tr_b16 v[114:115], v28 offset:1024
    v_mfma_f32_16x16x32_bf16 v[80:83], v[196:199], v[168:171], v[80:83]
    ds_read_b64_tr_b16 v[116:117], v26 offset:3584
    s_add_u32 s87, s71, s25
    v_add_u32 v44, s87, v1
    v_xor_b32 v45, 2048, v44
    v_xor_b32 v46, 4096, v44
    v_xor_b32 v47, 6144, v44
    v_mfma_f32_16x16x32_bf16 v[84:87], v[196:199], v[172:175], v[84:87]
    ds_read_b64_tr_b16 v[118:119], v30 offset:4608
    s_waitcnt lgkmcnt(12)
    v_mfma_f32_16x16x32_bf16 v[80:83], v[200:203], v[176:179], v[80:83]
    ds_read_b64_tr_b16 v[120:121], v24 offset:7168
    v_mfma_f32_16x16x32_bf16 v[84:87], v[200:203], v[180:183], v[84:87]
    ds_read_b64_tr_b16 v[122:123], v28 offset:8192
    v_mfma_f32_16x16x32_bf16 v[80:83], v[204:207], v[184:187], v[80:83]
    ds_read_b64_tr_b16 v[124:125], v26 offset:10752
    ds_write_b128 v47, v[88:91] offset:32768
    ds_write_b128 v47, v[92:95] offset:33792
    v_mfma_f32_16x16x32_bf16 v[84:87], v[204:207], v[188:191], v[84:87]
    ds_read_b64_tr_b16 v[126:127], v30 offset:11776
    s_waitcnt lgkmcnt(14)
    v_mfma_f32_16x16x32_bf16 v[72:75], v[96:99], v[160:163], v[72:75]
    v_mfma_f32_16x16x32_bf16 v[76:79], v[96:99], v[164:167], v[76:79]
    v_mfma_f32_16x16x32_bf16 v[72:75], v[100:103], v[168:171], v[72:75]
    v_mfma_f32_16x16x32_bf16 v[76:79], v[100:103], v[172:175], v[76:79]
    s_waitcnt lgkmcnt(10)
    v_mfma_f32_16x16x32_bf16 v[72:75], v[104:107], v[176:179], v[72:75]
    v_mfma_f32_16x16x32_bf16 v[76:79], v[104:107], v[180:183], v[76:79]
    v_mfma_f32_16x16x32_bf16 v[72:75], v[108:111], v[184:187], v[72:75]
    ds_write_b128 v46, v[80:83] offset:16384
    ds_write_b128 v46, v[84:87] offset:17408
    v_mfma_f32_16x16x32_bf16 v[76:79], v[108:111], v[188:191], v[76:79]
    s_waitcnt lgkmcnt(8)
    v_mfma_f32_16x16x32_bf16 v[64:67], v[112:115], v[160:163], v[64:67]
    v_mfma_f32_16x16x32_bf16 v[68:71], v[112:115], v[164:167], v[68:71]
    v_mfma_f32_16x16x32_bf16 v[64:67], v[116:119], v[168:171], v[64:67]
    v_mfma_f32_16x16x32_bf16 v[68:71], v[116:119], v[172:175], v[68:71]
    s_waitcnt lgkmcnt(2)
    v_mfma_f32_16x16x32_bf16 v[64:67], v[120:123], v[176:179], v[64:67]
    v_mfma_f32_16x16x32_bf16 v[68:71], v[120:123], v[180:183], v[68:71]
    v_mfma_f32_16x16x32_bf16 v[64:67], v[124:127], v[184:187], v[64:67]
    ds_write_b128 v45, v[72:75] offset:0
    ds_write_b128 v45, v[76:79] offset:1024
    v_mfma_f32_16x16x32_bf16 v[68:71], v[124:127], v[188:191], v[68:71]
    s_waitcnt lgkmcnt(0)
    s_barrier
    ds_read_b128 v[208:211], v44 offset:0
    ds_read_b128 v[212:215], v44 offset:1024
    ds_read_b128 v[216:219], v44 offset:16384
    ds_read_b128 v[220:223], v44 offset:17408
    ds_read_b128 v[224:227], v44 offset:32768
    ds_read_b128 v[228:231], v44 offset:33792
    s_waitcnt lgkmcnt(5)
    v_pk_add_f32 v[64:65], v[64:65], v[208:209]
    v_pk_add_f32 v[66:67], v[66:67], v[210:211]
    s_waitcnt lgkmcnt(4)
    v_pk_add_f32 v[68:69], v[68:69], v[212:213]
    v_pk_add_f32 v[70:71], v[70:71], v[214:215]
    s_waitcnt lgkmcnt(3)
    v_pk_add_f32 v[64:65], v[64:65], v[216:217]
    v_pk_add_f32 v[66:67], v[66:67], v[218:219]
    s_waitcnt lgkmcnt(2)
    v_pk_add_f32 v[68:69], v[68:69], v[220:221]
    v_pk_add_f32 v[70:71], v[70:71], v[222:223]
    s_waitcnt lgkmcnt(1)
    v_pk_add_f32 v[64:65], v[64:65], v[224:225]
    v_pk_add_f32 v[66:67], v[66:67], v[226:227]
    s_waitcnt lgkmcnt(0)
    v_pk_add_f32 v[68:69], v[68:69], v[228:229]
    v_pk_add_f32 v[70:71], v[70:71], v[230:231]
    v_cvt_pk_bf16_f32 v48, v64, v65
    v_cvt_pk_bf16_f32 v49, v66, v67
    v_cvt_pk_bf16_f32 v50, v68, v69
    v_cvt_pk_bf16_f32 v51, v70, v71
    s_nop 0
    v_permlane16_swap_b32 v48, v50
    v_permlane16_swap_b32 v49, v51
    buffer_store_dwordx4 v[48:51], v8, s[48:51], 0 offen
    s_branch L_tail
L_p3_late:
    s_cmp_eq_u32 s74, 0
    s_cbranch_scc1 L_p3_nx
    s_mov_b32 s93, 0
L_cwl:
    ds_read_b32 v37, v36
    s_add_u32 s93, s93, 1
    s_cmp_gt_u32 s93, 100000
    s_waitcnt lgkmcnt(0)
    v_cmp_gt_u32 vcc, 8, v37
    s_cbranch_scc1 L_cwl_ok
    s_cbranch_vccnz L_cwl
L_cwl_ok:
    s_setprio 0
L_p3_nx:
    s_waitcnt lgkmcnt(0)
    ds_read_b64_tr_b16 v[96:97], v56 offset:0
    ds_read_b64_tr_b16 v[98:99], v60 offset:1024
    ds_read_b64_tr_b16 v[100:101], v57 offset:0
    ds_read_b64_tr_b16 v[102:103], v61 offset:1024
    ds_read_b64_tr_b16 v[104:105], v58 offset:0
    ds_read_b64_tr_b16 v[106:107], v62 offset:1024
    ds_read_b64_tr_b16 v[108:109], v59 offset:0
    ds_read_b64_tr_b16 v[110:111], v63 offset:1024
    ds_read_b64_tr_b16 v[112:113], v58 offset:3584
    ds_read_b64_tr_b16 v[114:115], v62 offset:4608
    ds_read_b64_tr_b16 v[116:117], v59 offset:3584
    ds_read_b64_tr_b16 v[118:119], v63 offset:4608
    ds_read_b64_tr_b16 v[120:121], v56 offset:3584
    ds_read_b64_tr_b16 v[122:123], v60 offset:4608
    ds_read_b64_tr_b16 v[124:125], v57 offset:3584
    ds_read_b64_tr_b16 v[126:127], v61 offset:4608
L_oc0l:
    s_waitcnt vmcnt(4)
    v_xor_b32 v143, s58, v143
    v_xor_b32 v139, s58, v139
    v_xor_b32 v135, s58, v135
    v_xor_b32 v131, s58, v131
    v_or3_b32 v52, v143, v139, v135
    v_or_b32 v52, v52, v131
    v_cmp_lt_u32 vcc, 0xffff, v52
    s_cbranch_vccnz L_oc0l_r
L_oc0l_ok:
    s_waitcnt lgkmcnt(12)
    v_mfma_f32_16x16x32_bf16 v[64:67], v[96:99], v[128:131], 0
    ds_read_b64_tr_b16 v[192:193], v56 offset:7168
    v_mfma_f32_16x16x32_bf16 v[68:71], v[96:99], v[132:135], 0
    ds_read_b64_tr_b16 v[194:195], v60 offset:8192
    v_mfma_f32_16x16x32_bf16 v[76:79], v[100:103], v[132:135], 0
    ds_read_b64_tr_b16 v[196:197], v57 offset:7168
    v_mfma_f32_16x16x32_bf16 v[72:75], v[100:103], v[128:131], 0
    ds_read_b64_tr_b16 v[198:199], v61 offset:8192
    s_waitcnt lgkmcnt(12)
    v_mfma_f32_16x16x32_bf16 v[80:83], v[104:107], v[128:131], 0
    ds_read_b64_tr_b16 v[200:201], v58 offset:7168
    v_mfma_f32_16x16x32_bf16 v[84:87], v[104:107], v[132:135], 0
    ds_read_b64_tr_b16 v[202:203], v62 offset:8192
    v_mfma_f32_16x16x32_bf16 v[92:95], v[108:111], v[132:135], 0
    ds_read_b64_tr_b16 v[204:205], v59 offset:7168
    v_mfma_f32_16x16x32_bf16 v[88:91], v[108:111], v[128:131], 0
    ds_read_b64_tr_b16 v[206:207], v63 offset:8192
    s_waitcnt lgkmcnt(12)
    v_mfma_f32_16x16x32_bf16 v[64:67], v[112:115], v[136:139], v[64:67]
    ds_read_b64_tr_b16 v[96:97], v58 offset:10752
    v_mfma_f32_16x16x32_bf16 v[68:71], v[112:115], v[140:143], v[68:71]
    ds_read_b64_tr_b16 v[98:99], v62 offset:11776
    v_mfma_f32_16x16x32_bf16 v[76:79], v[116:119], v[140:143], v[76:79]
    ds_read_b64_tr_b16 v[100:101], v59 offset:10752
    v_mfma_f32_16x16x32_bf16 v[72:75], v[116:119], v[136:139], v[72:75]
    ds_read_b64_tr_b16 v[102:103], v63 offset:11776
    s_waitcnt lgkmcnt(12)
    v_mfma_f32_16x16x32_bf16 v[80:83], v[120:123], v[136:139], v[80:83]
    ds_read_b64_tr_b16 v[104:105], v56 offset:10752
    v_mfma_f32_16x16x32_bf16 v[84:87], v[120:123], v[140:143], v[84:87]
    ds_read_b64_tr_b16 v[106:107], v60 offset:11776
    v_mfma_f32_16x16x32_bf16 v[92:95], v[124:127], v[140:143], v[92:95]
    ds_read_b64_tr_b16 v[108:109], v57 offset:10752
L_oc2l:
    s_waitcnt vmcnt(0)
    v_xor_b32 v159, s58, v159
    v_xor_b32 v155, s58, v155
    v_xor_b32 v151, s58, v151
    v_xor_b32 v147, s58, v147
    v_or3_b32 v52, v159, v155, v151
    v_or_b32 v52, v52, v147
    v_cmp_lt_u32 vcc, 0xffff, v52
    s_cbranch_vccnz L_oc2l_r
L_oc2l_ok:
    v_mfma_f32_16x16x32_bf16 v[88:91], v[124:127], v[136:139], v[88:91]
    ds_read_b64_tr_b16 v[110:111], v61 offset:11776
    s_waitcnt lgkmcnt(12)
    v_mfma_f32_16x16x32_bf16 v[64:67], v[192:195], v[144:147], v[64:67]
    ds_read_b64_tr_b16 v[112:113], v27 offset:0
    v_mfma_f32_16x16x32_bf16 v[68:71], v[192:195], v[148:151], v[68:71]
    ds_read_b64_tr_b16 v[114:115], v31 offset:1024
    v_mfma_f32_16x16x32_bf16 v[76:79], v[196:199], v[148:151], v[76:79]
    ds_read_b64_tr_b16 v[116:117], v25 offset:3584
    v_mfma_f32_16x16x32_bf16 v[72:75], v[196:199], v[144:147], v[72:75]
    ds_read_b64_tr_b16 v[118:119], v29 offset:4608
    s_waitcnt lgkmcnt(12)
    v_mfma_f32_16x16x32_bf16 v[80:83], v[200:203], v[144:147], v[80:83]
    ds_read_b64_tr_b16 v[120:121], v27 offset:7168
    v_mfma_f32_16x16x32_bf16 v[84:87], v[200:203], v[148:151], v[84:87]
    ds_read_b64_tr_b16 v[122:123], v31 offset:8192
    v_mfma_f32_16x16x32_bf16 v[92:95], v[204:207], v[148:151], v[92:95]
    ds_read_b64_tr_b16 v[124:125], v25 offset:10752
    v_mfma_f32_16x16x32_bf16 v[88:91], v[204:207], v[144:147], v[88:91]
    ds_read_b64_tr_b16 v[126:127], v29 offset:11776
    s_waitcnt lgkmcnt(12)
    v_mfma_f32_16x16x32_bf16 v[64:67], v[96:99], v[152:155], v[64:67]
    ds_read_b64_tr_b16 v[192:193], v26 offset:0
    v_mfma_f32_16x16x32_bf16 v[68:71], v[96:99], v[156:159], v[68:71]
    ds_read_b64_tr_b16 v[194:195], v30 offset:1024
    v_mfma_f32_16x16x32_bf16 v[76:79], v[100:103], v[156:159], v[76:79]
    ds_read_b64_tr_b16 v[196:197], v24 offset:3584
    v_mfma_f32_16x16x32_bf16 v[72:75], v[100:103], v[152:155], v[72:75]
    ds_read_b64_tr_b16 v[198:199], v28 offset:4608
    s_waitcnt lgkmcnt(12)
    v_mfma_f32_16x16x32_bf16 v[80:83], v[104:107], v[152:155], v[80:83]
    ds_read_b64_tr_b16 v[200:201], v26 offset:7168
    v_mfma_f32_16x16x32_bf16 v[84:87], v[104:107], v[156:159], v[84:87]
    ds_read_b64_tr_b16 v[202:203], v30 offset:8192
    v_mfma_f32_16x16x32_bf16 v[92:95], v[108:111], v[156:159], v[92:95]
    ds_read_b64_tr_b16 v[204:205], v24 offset:10752
    v_mfma_f32_16x16x32_bf16 v[88:91], v[108:111], v[152:155], v[88:91]
    ds_read_b64_tr_b16 v[206:207], v28 offset:11776
    s_mov_b32 s93, 0
L_spin_p3b_l:
    s_load_dwordx4 s[32:35], s[56:57], s70 glc
    s_add_u32 s93, s93, 1
    s_cmp_gt_u32 s93, 100000
    s_waitcnt lgkmcnt(0)
    s_cbranch_scc1 L_go_p3b
    s_xor_b64 s[32:33], s[32:33], s[26:27]
    s_xor_b64 s[34:35], s[34:35], s[26:27]
    s_or_b64 s[32:33], s[32:33], s[34:35]
    s_cbranch_scc1 L_spin_p3b_l
L_go_p3b:
    s_add_u32 s99, s23, 0
    buffer_load_dwordx4 v[160:163], v53, s[36:39], s99 offen offset:0 sc1
    buffer_load_dwordx4 v[164:167], v53, s[36:39], s99 offen offset:256 sc1
    buffer_load_dwordx4 v[168:171], v53, s[36:39], s99 offen offset:2048 sc1
    buffer_load_dwordx4 v[172:175], v53, s[36:39], s99 offen offset:2304 sc1
    s_add_u32 s99, s23, 4096
    buffer_load_dwordx4 v[176:179], v53, s[36:39], s99 offen offset:0 sc1
    buffer_load_dwordx4 v[180:183], v53, s[36:39], s99 offen offset:256 sc1
    buffer_load_dwordx4 v[184:187], v53, s[36:39], s99 offen offset:2048 sc1
    buffer_load_dwordx4 v[188:191], v53, s[36:39], s99 offen offset:2304 sc1
    s_branch L_p3_join
L_p3_both:
    s_add_u32 s99, s23, 0
    buffer_load_dwordx4 v[160:163], v53, s[36:39], s99 offen offset:0 sc1
    buffer_load_dwordx4 v[164:167], v53, s[36:39], s99 offen offset:256 sc1
    buffer_load_dwordx4 v[168:171], v53, s[36:39], s99 offen offset:2048 sc1
    buffer_load_dwordx4 v[172:175], v53, s[36:39], s99 offen offset:2304 sc1
    s_add_u32 s99, s23, 4096
    buffer_load_dwordx4 v[176:179], v53, s[36:39], s99 offen offset:0 sc1
    buffer_load_dwordx4 v[180:183], v53, s[36:39], s99 offen offset:256 sc1
    buffer_load_dwordx4 v[184:187], v53, s[36:39], s99 offen offset:2048 sc1
    buffer_load_dwordx4 v[188:191], v53, s[36:39], s99 offen offset:2304 sc1
    s_mov_b32 s93, 0
L_cwb:
    ds_read_b32 v37, v36
    s_add_u32 s93, s93, 1
    s_cmp_gt_u32 s93, 100000
    s_waitcnt lgkmcnt(0)
    v_cmp_gt_u32 vcc, 8, v37
    s_cbranch_scc1 L_cwb_ok
    s_cbranch_vccnz L_cwb
L_cwb_ok:
    s_setprio 0
    s_waitcnt lgkmcnt(0)
    ds_read_b64_tr_b16 v[96:97], v56 offset:0
    ds_read_b64_tr_b16 v[98:99], v60 offset:1024
    ds_read_b64_tr_b16 v[100:101], v57 offset:0
    ds_read_b64_tr_b16 v[102:103], v61 offset:1024
    ds_read_b64_tr_b16 v[104:105], v58 offset:0
    ds_read_b64_tr_b16 v[106:107], v62 offset:1024
    ds_read_b64_tr_b16 v[108:109], v59 offset:0
    ds_read_b64_tr_b16 v[110:111], v63 offset:1024
    ds_read_b64_tr_b16 v[112:113], v58 offset:3584
    ds_read_b64_tr_b16 v[114:115], v62 offset:4608
    ds_read_b64_tr_b16 v[116:117], v59 offset:3584
    ds_read_b64_tr_b16 v[118:119], v63 offset:4608
    ds_read_b64_tr_b16 v[120:121], v56 offset:3584
    ds_read_b64_tr_b16 v[122:123], v60 offset:4608
    ds_read_b64_tr_b16 v[124:125], v57 offset:3584
    ds_read_b64_tr_b16 v[126:127], v61 offset:4608
L_oc0b:
    s_waitcnt vmcnt(12)
    v_xor_b32 v143, s58, v143
    v_xor_b32 v139, s58, v139
    v_xor_b32 v135, s58, v135
    v_xor_b32 v131, s58, v131
    v_or3_b32 v52, v143, v139, v135
    v_or_b32 v52, v52, v131
    v_cmp_lt_u32 vcc, 0xffff, v52
    s_cbranch_vccnz L_oc0b_r
L_oc0b_ok:
    s_waitcnt lgkmcnt(12)
    v_mfma_f32_16x16x32_bf16 v[64:67], v[96:99], v[128:131], 0
    ds_read_b64_tr_b16 v[192:193], v56 offset:7168
    v_mfma_f32_16x16x32_bf16 v[68:71], v[96:99], v[132:135], 0
    ds_read_b64_tr_b16 v[194:195], v60 offset:8192
    v_mfma_f32_16x16x32_bf16 v[76:79], v[100:103], v[132:135], 0
    ds_read_b64_tr_b16 v[196:197], v57 offset:7168
    v_mfma_f32_16x16x32_bf16 v[72:75], v[100:103], v[128:131], 0
    ds_read_b64_tr_b16 v[198:199], v61 offset:8192
    s_waitcnt lgkmcnt(12)
    v_mfma_f32_16x16x32_bf16 v[80:83], v[104:107], v[128:131], 0
    ds_read_b64_tr_b16 v[200:201], v58 offset:7168
    v_mfma_f32_16x16x32_bf16 v[84:87], v[104:107], v[132:135], 0
    ds_read_b64_tr_b16 v[202:203], v62 offset:8192
    v_mfma_f32_16x16x32_bf16 v[92:95], v[108:111], v[132:135], 0
    ds_read_b64_tr_b16 v[204:205], v59 offset:7168
    v_mfma_f32_16x16x32_bf16 v[88:91], v[108:111], v[128:131], 0
    ds_read_b64_tr_b16 v[206:207], v63 offset:8192
    s_waitcnt lgkmcnt(12)
    v_mfma_f32_16x16x32_bf16 v[64:67], v[112:115], v[136:139], v[64:67]
    ds_read_b64_tr_b16 v[96:97], v58 offset:10752
    v_mfma_f32_16x16x32_bf16 v[68:71], v[112:115], v[140:143], v[68:71]
    ds_read_b64_tr_b16 v[98:99], v62 offset:11776
    v_mfma_f32_16x16x32_bf16 v[76:79], v[116:119], v[140:143], v[76:79]
    ds_read_b64_tr_b16 v[100:101], v59 offset:10752
    v_mfma_f32_16x16x32_bf16 v[72:75], v[116:119], v[136:139], v[72:75]
    ds_read_b64_tr_b16 v[102:103], v63 offset:11776
    s_waitcnt lgkmcnt(12)
    v_mfma_f32_16x16x32_bf16 v[80:83], v[120:123], v[136:139], v[80:83]
    ds_read_b64_tr_b16 v[104:105], v56 offset:10752
    v_mfma_f32_16x16x32_bf16 v[84:87], v[120:123], v[140:143], v[84:87]
    ds_read_b64_tr_b16 v[106:107], v60 offset:11776
    v_mfma_f32_16x16x32_bf16 v[92:95], v[124:127], v[140:143], v[92:95]
    ds_read_b64_tr_b16 v[108:109], v57 offset:10752
L_oc2b:
    s_waitcnt vmcnt(8)
    v_xor_b32 v159, s58, v159
    v_xor_b32 v155, s58, v155
    v_xor_b32 v151, s58, v151
    v_xor_b32 v147, s58, v147
    v_or3_b32 v52, v159, v155, v151
    v_or_b32 v52, v52, v147
    v_cmp_lt_u32 vcc, 0xffff, v52
    s_cbranch_vccnz L_oc2b_r
L_oc2b_ok:
    v_mfma_f32_16x16x32_bf16 v[88:91], v[124:127], v[136:139], v[88:91]
    ds_read_b64_tr_b16 v[110:111], v61 offset:11776
    s_waitcnt lgkmcnt(12)
    v_mfma_f32_16x16x32_bf16 v[64:67], v[192:195], v[144:147], v[64:67]
    ds_read_b64_tr_b16 v[112:113], v27 offset:0
    v_mfma_f32_16x16x32_bf16 v[68:71], v[192:195], v[148:151], v[68:71]
    ds_read_b64_tr_b16 v[114:115], v31 offset:1024
    v_mfma_f32_16x16x32_bf16 v[76:79], v[196:199], v[148:151], v[76:79]
    ds_read_b64_tr_b16 v[116:117], v25 offset:3584
    v_mfma_f32_16x16x32_bf16 v[72:75], v[196:199], v[144:147], v[72:75]
    ds_read_b64_tr_b16 v[118:119], v29 offset:4608
    s_waitcnt lgkmcnt(12)
    v_mfma_f32_16x16x32_bf16 v[80:83], v[200:203], v[144:147], v[80:83]
    ds_read_b64_tr_b16 v[120:121], v27 offset:7168
    v_mfma_f32_16x16x32_bf16 v[84:87], v[200:203], v[148:151], v[84:87]
    ds_read_b64_tr_b16 v[122:123], v31 offset:8192
    v_mfma_f32_16x16x32_bf16 v[92:95], v[204:207], v[148:151], v[92:95]
    ds_read_b64_tr_b16 v[124:125], v25 offset:10752
    v_mfma_f32_16x16x32_bf16 v[88:91], v[204:207], v[144:147], v[88:91]
    ds_read_b64_tr_b16 v[126:127], v29 offset:11776
    s_waitcnt lgkmcnt(12)
    v_mfma_f32_16x16x32_bf16 v[64:67], v[96:99], v[152:155], v[64:67]
    ds_read_b64_tr_b16 v[192:193], v26 offset:0
    v_mfma_f32_16x16x32_bf16 v[68:71], v[96:99], v[156:159], v[68:71]
    ds_read_b64_tr_b16 v[194:195], v30 offset:1024
    v_mfma_f32_16x16x32_bf16 v[76:79], v[100:103], v[156:159], v[76:79]
    ds_read_b64_tr_b16 v[196:197], v24 offset:3584
    v_mfma_f32_16x16x32_bf16 v[72:75], v[100:103], v[152:155], v[72:75]
    ds_read_b64_tr_b16 v[198:199], v28 offset:4608
    s_waitcnt lgkmcnt(12)
    v_mfma_f32_16x16x32_bf16 v[80:83], v[104:107], v[152:155], v[80:83]
    ds_read_b64_tr_b16 v[200:201], v26 offset:7168
    v_mfma_f32_16x16x32_bf16 v[84:87], v[104:107], v[156:159], v[84:87]
    ds_read_b64_tr_b16 v[202:203], v30 offset:8192
    v_mfma_f32_16x16x32_bf16 v[92:95], v[108:111], v[156:159], v[92:95]
    ds_read_b64_tr_b16 v[204:205], v24 offset:10752
    v_mfma_f32_16x16x32_bf16 v[88:91], v[108:111], v[152:155], v[88:91]
    ds_read_b64_tr_b16 v[206:207], v28 offset:11776
    s_branch L_p3_join
L_B1:
    ds_read_b64_tr_b16 v[64:65], v44 offset:32768
    ds_read_b64_tr_b16 v[66:67], v44 offset:33280
    ds_read_b64_tr_b16 v[68:69], v45 offset:32768
    ds_read_b64_tr_b16 v[70:71], v45 offset:33280
    ds_read_b64_tr_b16 v[72:73], v44 offset:36864
    ds_read_b64_tr_b16 v[74:75], v44 offset:37376
    ds_read_b64_tr_b16 v[76:77], v45 offset:36864
    ds_read_b64_tr_b16 v[78:79], v45 offset:37376
    s_waitcnt lgkmcnt(6)
    v_mfma_f32_16x16x32_bf16 v[96:99], v[64:67], v[176:179], v[96:99]
    s_waitcnt lgkmcnt(4)
    v_mfma_f32_16x16x32_bf16 v[104:107], v[68:71], v[176:179], v[104:107]
    v_mfma_f32_16x16x32_bf16 v[108:111], v[68:71], v[180:183], v[108:111]
    v_mfma_f32_16x16x32_bf16 v[100:103], v[64:67], v[180:183], v[100:103]
    s_waitcnt lgkmcnt(2)
    v_mfma_f32_16x16x32_bf16 v[96:99], v[72:75], v[184:187], v[96:99]
    s_waitcnt lgkmcnt(0)
    v_mfma_f32_16x16x32_bf16 v[104:107], v[76:79], v[184:187], v[104:107]
    v_mfma_f32_16x16x32_bf16 v[108:111], v[76:79], v[188:191], v[108:111]
    v_mfma_f32_16x16x32_bf16 v[100:103], v[72:75], v[188:191], v[100:103]
    s_add_u32 m0, s72, 8192
    s_mov_b64 exec, s[8:9]
    buffer_load_dwordx4 v35, s[32:35], s85 offen offset:0 lds
    s_mov_b64 exec, -1
    s_add_u32 m0, s72, 0
    s_mov_b64 exec, s[8:9]
    buffer_load_dwordx4 v35, s[32:35], s86 offen offset:0 lds
    s_mov_b64 exec, -1
    s_waitcnt vmcnt(2)
    s_barrier
    ds_read_b64_tr_b16 v[80:81], v44 offset:24576
    ds_read_b64_tr_b16 v[82:83], v44 offset:25088
    ds_read_b64_tr_b16 v[84:85], v45 offset:24576
    ds_read_b64_tr_b16 v[86:87], v45 offset:25088
    ds_read_b64_tr_b16 v[88:89], v44 offset:28672
    ds_read_b64_tr_b16 v[90:91], v44 offset:29184
    ds_read_b64_tr_b16 v[92:93], v45 offset:28672
    ds_read_b64_tr_b16 v[94:95], v45 offset:29184
    s_waitcnt lgkmcnt(6)
    v_mfma_f32_16x16x32_bf16 v[96:99], v[80:83], v[192:195], v[96:99]
    ds_read_b64_tr_b16 v[64:65], v44 offset:16384
    s_waitcnt lgkmcnt(5)
    v_mfma_f32_16x16x32_bf16 v[104:107], v[84:87], v[192:195], v[104:107]
    ds_read_b64_tr_b16 v[66:67], v44 offset:16896
    v_mfma_f32_16x16x32_bf16 v[108:111], v[84:87], v[196:199], v[108:111]
    ds_read_b64_tr_b16 v[68:69], v45 offset:16384
    v_mfma_f32_16x16x32_bf16 v[100:103], v[80:83], v[196:199], v[100:103]
    ds_read_b64_tr_b16 v[70:71], v45 offset:16896
    s_waitcnt lgkmcnt(6)
    v_mfma_f32_16x16x32_bf16 v[96:99], v[88:91], v[200:203], v[96:99]
    ds_read_b64_tr_b16 v[72:73], v44 offset:20480
    s_waitcnt lgkmcnt(5)
    v_mfma_f32_16x16x32_bf16 v[104:107], v[92:95], v[200:203], v[104:107]
    ds_read_b64_tr_b16 v[74:75], v44 offset:20992
    v_mfma_f32_16x16x32_bf16 v[108:111], v[92:95], v[204:207], v[108:111]
    ds_read_b64_tr_b16 v[76:77], v45 offset:20480
    v_mfma_f32_16x16x32_bf16 v[100:103], v[88:91], v[204:207], v[100:103]
    ds_read_b64_tr_b16 v[78:79], v45 offset:20992
    s_waitcnt lgkmcnt(6)
    v_mfma_f32_16x16x32_bf16 v[96:99], v[64:67], v[208:211], v[96:99]
    s_waitcnt lgkmcnt(4)
    v_mfma_f32_16x16x32_bf16 v[104:107], v[68:71], v[208:211], v[104:107]
    v_mfma_f32_16x16x32_bf16 v[108:111], v[68:71], v[212:215], v[108:111]
    v_mfma_f32_16x16x32_bf16 v[100:103], v[64:67], v[212:215], v[100:103]
    s_waitcnt lgkmcnt(2)
    v_mfma_f32_16x16x32_bf16 v[96:99], v[72:75], v[216:219], v[96:99]
    s_waitcnt lgkmcnt(0)
    v_mfma_f32_16x16x32_bf16 v[104:107], v[76:79], v[216:219], v[104:107]
    v_mfma_f32_16x16x32_bf16 v[108:111], v[76:79], v[220:223], v[108:111]
    v_mfma_f32_16x16x32_bf16 v[100:103], v[72:75], v[220:223], v[100:103]
    s_and_b32 s87, s71, 0x1fff
    s_mul_i32 s80, s73, 448
    s_lshl_b32 s73, s73, 6
    s_add_u32 s73, s73, s87
    s_mul_i32 s81, s74, 448
    s_lshl_b32 s74, s74, 6
    s_add_u32 s74, s74, s87
    s_mul_i32 s82, s75, 448
    s_lshl_b32 s75, s75, 6
    s_add_u32 s75, s75, s87
    s_mul_i32 s83, s76, 448
    s_lshl_b32 s76, s76, 6
    s_add_u32 s76, s76, s87
    s_mul_i32 s84, s77, 448
    s_lshl_b32 s77, s77, 6
    s_add_u32 s77, s77, s87
    s_mul_i32 s85, s78, 448
    s_lshl_b32 s78, s78, 6
    s_add_u32 s78, s78, s87
    s_mul_i32 s86, s79, 448
    s_lshl_b32 s79, s79, 6
    s_add_u32 s79, s79, s87
    s_waitcnt vmcnt(0)
    s_barrier
    ds_read_b64_tr_b16 v[80:81], v44 offset:8192
    ds_read_b64_tr_b16 v[82:83], v44 offset:8704
    ds_read_b64_tr_b16 v[84:85], v45 offset:8192
    ds_read_b64_tr_b16 v[86:87], v45 offset:8704
    ds_read_b64_tr_b16 v[88:89], v44 offset:12288
    ds_read_b64_tr_b16 v[90:91], v44 offset:12800
    ds_read_b64_tr_b16 v[92:93], v45 offset:12288
    ds_read_b64_tr_b16 v[94:95], v45 offset:12800
    s_waitcnt lgkmcnt(6)
    v_mfma_f32_16x16x32_bf16 v[96:99], v[80:83], v[224:227], v[96:99]
    ds_read_b64_tr_b16 v[64:65], v44 offset:0
    s_waitcnt lgkmcnt(5)
    v_mfma_f32_16x16x32_bf16 v[104:107], v[84:87], v[224:227], v[104:107]
    ds_read_b64_tr_b16 v[66:67], v44 offset:512
    v_mfma_f32_16x16x32_bf16 v[108:111], v[84:87], v[228:231], v[108:111]
    ds_read_b64_tr_b16 v[68:69], v45 offset:0
    v_mfma_f32_16x16x32_bf16 v[100:103], v[80:83], v[228:231], v[100:103]
    ds_read_b64_tr_b16 v[70:71], v45 offset:512
    s_waitcnt lgkmcnt(6)
    v_mfma_f32_16x16x32_bf16 v[96:99], v[88:91], v[232:235], v[96:99]
    ds_read_b64_tr_b16 v[72:73], v44 offset:4096
    s_waitcnt lgkmcnt(5)
    v_mfma_f32_16x16x32_bf16 v[104:107], v[92:95], v[232:235], v[104:107]
    ds_read_b64_tr_b16 v[74:75], v44 offset:4608
    v_mfma_f32_16x16x32_bf16 v[108:111], v[92:95], v[236:239], v[108:111]
    ds_read_b64_tr_b16 v[76:77], v45 offset:4096
    v_mfma_f32_16x16x32_bf16 v[100:103], v[88:91], v[236:239], v[100:103]
    ds_read_b64_tr_b16 v[78:79], v45 offset:4608
    s_waitcnt lgkmcnt(6)
    v_mfma_f32_16x16x32_bf16 v[96:99], v[64:67], v[240:243], v[96:99]
    s_waitcnt lgkmcnt(4)
    v_mfma_f32_16x16x32_bf16 v[104:107], v[68:71], v[240:243], v[104:107]
    v_mfma_f32_16x16x32_bf16 v[108:111], v[68:71], v[244:247], v[108:111]
    v_mfma_f32_16x16x32_bf16 v[100:103], v[64:67], v[244:247], v[100:103]
    s_waitcnt lgkmcnt(2)
    v_mfma_f32_16x16x32_bf16 v[96:99], v[72:75], v[248:251], v[96:99]
    s_waitcnt lgkmcnt(0)
    v_mfma_f32_16x16x32_bf16 v[104:107], v[76:79], v[248:251], v[104:107]
    v_mfma_f32_16x16x32_bf16 v[108:111], v[76:79], v[252:255], v[108:111]
    v_mfma_f32_16x16x32_bf16 v[100:103], v[72:75], v[252:255], v[100:103]
    s_barrier
    s_waitcnt lgkmcnt(0)
    s_cmp_eq_u32 s66, 7
    s_cbranch_scc1 L_w7
    s_mul_i32 s23, s62, 896
    s_add_u32 s23, s23, s15
    s_add_u32 s23, s23, 0x300000
    s_mov_b64 exec, s[12:13]
    s_add_u32 m0, s16, 57344
    s_add_u32 s99, s23, 0
    buffer_load_dwordx4 v9, s[36:39], s99 offen sc1 lds
    s_add_u32 m0, s16, 81920
    s_add_u32 s99, s23, 448
    buffer_load_dwordx4 v9, s[36:39], s99 offen sc1 lds
    s_add_u32 m0, s16, 58368
    s_add_u32 s99, s23, 14336
    buffer_load_dwordx4 v9, s[36:39], s99 offen sc1 lds
    s_add_u32 m0, s16, 82944
    s_add_u32 s99, s23, 14784
    buffer_load_dwordx4 v9, s[36:39], s99 offen sc1 lds
    s_add_u32 m0, s16, 59392
    s_add_u32 s99, s23, 28672
    buffer_load_dwordx4 v9, s[36:39], s99 offen sc1 lds
    s_add_u32 m0, s16, 83968
    s_add_u32 s99, s23, 29120
    buffer_load_dwordx4 v9, s[36:39], s99 offen sc1 lds
    s_add_u32 m0, s16, 60416
    s_add_u32 s99, s23, 43008
    buffer_load_dwordx4 v9, s[36:39], s99 offen sc1 lds
    s_add_u32 m0, s16, 84992
    s_add_u32 s99, s23, 43456
    buffer_load_dwordx4 v9, s[36:39], s99 offen sc1 lds
    s_add_u32 m0, s16, 61440
    s_add_u32 s99, s23, 57344
    buffer_load_dwordx4 v9, s[36:39], s99 offen sc1 lds
    s_add_u32 m0, s16, 86016
    s_add_u32 s99, s23, 57792
    buffer_load_dwordx4 v9, s[36:39], s99 offen sc1 lds
    s_add_u32 m0, s16, 62464
    s_add_u32 s99, s23, 71680
    buffer_load_dwordx4 v9, s[36:39], s99 offen sc1 lds
    s_add_u32 m0, s16, 87040
    s_add_u32 s99, s23, 72128
    buffer_load_dwordx4 v9, s[36:39], s99 offen sc1 lds
    s_add_u32 m0, s16, 63488
    s_add_u32 s99, s23, 86016
    buffer_load_dwordx4 v9, s[36:39], s99 offen sc1 lds
    s_add_u32 m0, s16, 88064
    s_add_u32 s99, s23, 86464
    buffer_load_dwordx4 v9, s[36:39], s99 offen sc1 lds
    s_add_u32 m0, s16, 64512
    s_add_u32 s99, s23, 100352
    buffer_load_dwordx4 v9, s[36:39], s99 offen sc1 lds
    s_add_u32 m0, s16, 89088
    s_add_u32 s99, s23, 100800
    buffer_load_dwordx4 v9, s[36:39], s99 offen sc1 lds
    s_mov_b64 exec, -1
L_w7:
    s_setprio 2
    s_nop 1
    v_mul_f32 v4, 0x3fb8aa3b, v108
    v_mul_f32 v12, 0x3fb8aa3b, v104
    s_nop 1
    v_permlane16_swap_b32 v12, v4
    v_mov_b32 v12, v4
    s_nop 1
    v_permlane32_swap_b32 v12, v4
    v_exp_f32 v4, v4
    s_nop 0
    v_add_f32 v4, 1.0, v4
    v_rcp_f32 v4, v4
    v_mul_f32 v96, 0x3e8b97f6, v96
    v_mul_f32 v97, 0x3e8b97f6, v97
    v_cvt_pk_bf16_f32 v24, v96, v97
    v_mul_f32 v98, 0x3e8b97f6, v98
    v_mul_f32 v99, 0x3e8b97f6, v99
    v_cvt_pk_bf16_f32 v25, v98, v99
    v_mul_f32 v100, 0x3e8b97f6, v100
    v_mul_f32 v101, 0x3e8b97f6, v101
    v_cvt_pk_bf16_f32 v26, v100, v101
    v_mul_f32 v102, 0x3e8b97f6, v102
    v_mul_f32 v103, 0x3e8b97f6, v103
    v_cvt_pk_bf16_f32 v27, v102, v103
    v_mul_f32 v104, 0x3e8b97f6, v104
    v_mul_f32 v105, 0x3e8b97f6, v105
    v_cvt_pk_bf16_f32 v28, v104, v105
    v_mul_f32 v106, 0x3e8b97f6, v106
    v_mul_f32 v107, 0x3e8b97f6, v107
    v_cvt_pk_bf16_f32 v29, v106, v107
    v_mul_f32 v108, 0x3e8b97f6, v108
    v_mul_f32 v109, 0x3e8b97f6, v109
    v_cvt_pk_bf16_f32 v30, v108, v109
    v_mul_f32 v110, 0x3e8b97f6, v110
    v_mul_f32 v111, 0x3e8b97f6, v111
    v_cvt_pk_bf16_f32 v31, v110, v111
    v_bfe_u32 v12, v0, 3, 1
    v_mul_u32_u24 v12, 120, v12
    v_permlane16_swap_b32 v24, v26
    v_permlane16_swap_b32 v25, v27
    v_permlane16_swap_b32 v28, v30
    v_permlane16_swap_b32 v29, v31
    v_bfe_u32 v13, v0, 4, 1
    v_cndmask_b32 v30, v30, 1.0, s[90:91]
    v_lshl_add_u32 v12, v13, 7, v12
    v_sub_u32 v12, v10, v12
    v_add_u32 v12, 57344, v12
    s_setprio 2
    ds_read_b64 v[64:65], v12 offset:0
    ds_read_b64 v[66:67], v12 offset:256
    ds_read_b64 v[68:69], v12 offset:1024
    ds_read_b64 v[70:71], v12 offset:1280
    ds_read_b64 v[72:73], v12 offset:2048
    ds_read_b64 v[74:75], v12 offset:2304
    ds_read_b64 v[76:77], v12 offset:3072
    ds_read_b64 v[78:79], v12 offset:3328
    ds_read_b64 v[80:81], v12 offset:4096
    ds_read_b64 v[82:83], v12 offset:4352
    ds_read_b64 v[84:85], v12 offset:5120
    ds_read_b64 v[86:87], v12 offset:5376
    ds_read_b64 v[88:89], v12 offset:6144
    ds_read_b64 v[90:91], v12 offset:6400
    ds_read_b64 v[92:93], v12 offset:7168
    ds_read_b64 v[94:95], v12 offset:7424
    s_waitcnt lgkmcnt(14)
    v_mfma_f32_32x32x16_bf16 v[112:127], v[64:67], v[24:27], v[112:127]
    s_waitcnt lgkmcnt(12)
    v_mfma_f32_32x32x16_bf16 v[112:127], v[68:71], v[28:31], v[112:127]
    ds_read_b64 v[64:65], v12 offset:8192
    ds_read_b64 v[66:67], v12 offset:8448
    ds_read_b64 v[68:69], v12 offset:9216
    ds_read_b64 v[70:71], v12 offset:9472
    s_waitcnt lgkmcnt(14)
    v_mfma_f32_32x32x16_bf16 v[144:159], v[72:75], v[24:27], 0
    s_waitcnt lgkmcnt(12)
    v_mfma_f32_32x32x16_bf16 v[144:159], v[76:79], v[28:31], v[144:159]
    ds_read_b64 v[72:73], v12 offset:10240
    ds_read_b64 v[74:75], v12 offset:10496
    ds_read_b64 v[76:77], v12 offset:11264
    ds_read_b64 v[78:79], v12 offset:11520
    s_waitcnt lgkmcnt(14)
    v_mfma_f32_32x32x16_bf16 v[160:175], v[80:83], v[24:27], 0
    s_waitcnt lgkmcnt(12)
    v_mfma_f32_32x32x16_bf16 v[160:175], v[84:87], v[28:31], v[160:175]
    ds_read_b64 v[80:81], v12 offset:12288
    ds_read_b64 v[82:83], v12 offset:12544
    ds_read_b64 v[84:85], v12 offset:13312
    ds_read_b64 v[86:87], v12 offset:13568
    s_waitcnt lgkmcnt(14)
    v_mfma_f32_32x32x16_bf16 v[176:191], v[88:91], v[24:27], 0
    s_waitcnt lgkmcnt(12)
    v_mfma_f32_32x32x16_bf16 v[176:191], v[92:95], v[28:31], v[176:191]
    ds_read_b64 v[88:89], v12 offset:14336
    ds_read_b64 v[90:91], v12 offset:14592
    ds_read_b64 v[92:93], v12 offset:15360
    ds_read_b64 v[94:95], v12 offset:15616
    s_waitcnt lgkmcnt(14)
    v_mfma_f32_32x32x16_bf16 v[192:207], v[64:67], v[24:27], 0
    s_waitcnt lgkmcnt(12)
    v_mfma_f32_32x32x16_bf16 v[192:207], v[68:71], v[28:31], v[192:207]
    ds_read_b64 v[64:65], v12 offset:16384
    ds_read_b64 v[66:67], v12 offset:16640
    ds_read_b64 v[68:69], v12 offset:17408
    ds_read_b64 v[70:71], v12 offset:17664
    s_waitcnt lgkmcnt(14)
    v_mfma_f32_32x32x16_bf16 v[208:223], v[72:75], v[24:27], 0
    s_waitcnt lgkmcnt(12)
    v_mfma_f32_32x32x16_bf16 v[208:223], v[76:79], v[28:31], v[208:223]
    s_waitcnt lgkmcnt(10)
    v_mfma_f32_32x32x16_bf16 v[224:239], v[80:83], v[24:27], 0
    s_waitcnt lgkmcnt(8)
    v_mfma_f32_32x32x16_bf16 v[224:239], v[84:87], v[28:31], v[224:239]
    s_waitcnt lgkmcnt(6)
    v_mfma_f32_32x32x16_bf16 v[240:255], v[88:91], v[24:27], 0
    s_waitcnt lgkmcnt(4)
    v_mfma_f32_32x32x16_bf16 v[240:255], v[92:95], v[28:31], v[240:255]
    s_waitcnt lgkmcnt(2)
    v_mfma_f32_32x32x16_bf16 v[128:143], v[64:67], v[24:27], v[128:143]
    s_waitcnt lgkmcnt(0)
    v_mfma_f32_32x32x16_bf16 v[128:143], v[68:71], v[28:31], v[128:143]
    s_setprio 0
    s_add_u32 m0, s73, 0
    s_nop 0
    buffer_load_dwordx4 v2, s[40:43], s80 offen lds
    buffer_load_dwordx4 v3, s[40:43], s80 offen offset:1024 lds
    s_add_u32 m0, s74, 0
    s_nop 0
    buffer_load_dwordx4 v2, s[40:43], s81 offen lds
    buffer_load_dwordx4 v3, s[40:43], s81 offen offset:1024 lds
    s_add_u32 m0, s75, 0
    s_nop 0
    buffer_load_dwordx4 v2, s[40:43], s82 offen lds
    buffer_load_dwordx4 v3, s[40:43], s82 offen offset:1024 lds
    s_add_u32 m0, s76, 0
    s_nop 0
    buffer_load_dwordx4 v2, s[40:43], s83 offen lds
    buffer_load_dwordx4 v3, s[40:43], s83 offen offset:1024 lds
    s_waitcnt vmcnt(8)
    s_barrier
    ds_read_b128 v[64:67], v10 offset:0
    ds_read_b128 v[68:71], v10 offset:1024
    ds_read_b128 v[72:75], v10 offset:2048
    ds_read_b128 v[76:79], v10 offset:3072
    ds_read_b128 v[80:83], v10 offset:4096
    ds_read_b128 v[84:87], v10 offset:5120
    ds_read_b128 v[88:91], v10 offset:6144
    ds_read_b128 v[92:95], v10 offset:7168
    s_add_u32 m0, s77, 0
    s_nop 0
    buffer_load_dwordx4 v2, s[40:43], s84 offen lds
    buffer_load_dwordx4 v3, s[40:43], s84 offen offset:1024 lds
    s_add_u32 m0, s78, 0
    s_nop 0
    buffer_load_dwordx4 v2, s[40:43], s85 offen lds
    buffer_load_dwordx4 v3, s[40:43], s85 offen offset:1024 lds
    s_add_u32 m0, s79, 0
    s_nop 0
    buffer_load_dwordx4 v2, s[40:43], s86 offen lds
    buffer_load_dwordx4 v3, s[40:43], s86 offen offset:1024 lds
    s_add_u32 m0, s73, 106496
    s_nop 0
    buffer_load_dwordx4 v2, s[44:47], s80 offen lds
    buffer_load_dwordx4 v3, s[44:47], s80 offen offset:1024 lds
    s_add_u32 m0, s74, 106496
    s_nop 0
    buffer_load_dwordx4 v2, s[44:47], s81 offen lds
    buffer_load_dwordx4 v3, s[44:47], s81 offen offset:1024 lds
    s_add_u32 m0, s75, 106496
    s_nop 0
    buffer_load_dwordx4 v2, s[44:47], s82 offen lds
    buffer_load_dwordx4 v3, s[44:47], s82 offen offset:1024 lds
    s_add_u32 m0, s76, 106496
    s_nop 0
    buffer_load_dwordx4 v2, s[44:47], s83 offen lds
    buffer_load_dwordx4 v3, s[44:47], s83 offen offset:1024 lds
    s_add_u32 m0, s77, 106496
    s_nop 0
    buffer_load_dwordx4 v2, s[44:47], s84 offen lds
    buffer_load_dwordx4 v3, s[44:47], s84 offen offset:1024 lds
    v_exp_f32 v112, v112
    v_exp_f32 v113, v113
    v_exp_f32 v114, v114
    v_exp_f32 v115, v115
    v_cvt_pk_bf16_f32 v112, v112, v113
    v_exp_f32 v116, v116
    v_exp_f32 v117, v117
    v_cvt_pk_bf16_f32 v113, v114, v115
    v_exp_f32 v118, v118
    v_exp_f32 v119, v119
    v_cvt_pk_bf16_f32 v114, v116, v117
    v_exp_f32 v120, v120
    v_exp_f32 v121, v121
    v_cvt_pk_bf16_f32 v115, v118, v119
    v_exp_f32 v122, v122
    v_exp_f32 v123, v123
    v_cvt_pk_bf16_f32 v116, v120, v121
    v_exp_f32 v124, v124
    v_exp_f32 v125, v125
    v_cvt_pk_bf16_f32 v117, v122, v123
    v_exp_f32 v126, v126
    v_exp_f32 v127, v127
    v_cvt_pk_bf16_f32 v118, v124, v125
    v_cvt_pk_bf16_f32 v119, v126, v127
    v_exp_f32 v144, v144
    s_waitcnt lgkmcnt(7)
    v_mfma_f32_32x32x16_bf16 v[48:63], v[64:67], v[112:115], 0
    v_exp_f32 v145, v145
    v_exp_f32 v146, v146
    v_exp_f32 v147, v147
    v_cvt_pk_bf16_f32 v144, v144, v145
    v_exp_f32 v148, v148
    v_exp_f32 v149, v149
    v_cvt_pk_bf16_f32 v145, v146, v147
    s_waitcnt lgkmcnt(6)
    v_mfma_f32_32x32x16_bf16 v[48:63], v[68:71], v[116:119], v[48:63]
    v_exp_f32 v150, v150
    v_exp_f32 v151, v151
    v_cvt_pk_bf16_f32 v146, v148, v149
    v_exp_f32 v152, v152
    v_exp_f32 v153, v153
    v_cvt_pk_bf16_f32 v147, v150, v151
    v_exp_f32 v154, v154
    v_exp_f32 v155, v155
    ds_read_b128 v[64:67], v10 offset:8192
    v_cvt_pk_bf16_f32 v148, v152, v153
    v_exp_f32 v156, v156
    v_exp_f32 v157, v157
    ds_read_b128 v[68:71], v10 offset:9216
    v_cvt_pk_bf16_f32 v149, v154, v155
    v_exp_f32 v158, v158
    v_exp_f32 v159, v159
    v_cvt_pk_bf16_f32 v150, v156, v157
    v_cvt_pk_bf16_f32 v151, v158, v159
    v_exp_f32 v160, v160
    s_waitcnt lgkmcnt(7)
    v_mfma_f32_32x32x16_bf16 v[48:63], v[72:75], v[144:147], v[48:63]
    v_exp_f32 v161, v161
    v_exp_f32 v162, v162
    v_exp_f32 v163, v163
    v_cvt_pk_bf16_f32 v160, v160, v161
    v_exp_f32 v164, v164
    v_exp_f32 v165, v165
    v_cvt_pk_bf16_f32 v161, v162, v163
    s_waitcnt lgkmcnt(6)
    v_mfma_f32_32x32x16_bf16 v[48:63], v[76:79], v[148:151], v[48:63]
    v_exp_f32 v166, v166
    v_exp_f32 v167, v167
    v_cvt_pk_bf16_f32 v162, v164, v165
    v_exp_f32 v168, v168
    v_exp_f32 v169, v169
    v_cvt_pk_bf16_f32 v163, v166, v167
    v_exp_f32 v170, v170
    v_exp_f32 v171, v171
    ds_read_b128 v[72:75], v10 offset:10240
    v_cvt_pk_bf16_f32 v164, v168, v169
    v_exp_f32 v172, v172
    v_exp_f32 v173, v173
    ds_read_b128 v[76:79], v10 offset:11264
    v_cvt_pk_bf16_f32 v165, v170, v171
    v_exp_f32 v174, v174
    v_exp_f32 v175, v175
    v_cvt_pk_bf16_f32 v166, v172, v173
    v_cvt_pk_bf16_f32 v167, v174, v175
    s_setprio 1
    v_exp_f32 v176, v176
    s_waitcnt lgkmcnt(7)
    v_mfma_f32_32x32x16_bf16 v[48:63], v[80:83], v[160:163], v[48:63]
    v_exp_f32 v177, v177
    v_exp_f32 v178, v178
    v_exp_f32 v179, v179
    v_cvt_pk_bf16_f32 v176, v176, v177
    v_exp_f32 v180, v180
    v_exp_f32 v181, v181
    v_cvt_pk_bf16_f32 v177, v178, v179
    s_waitcnt lgkmcnt(6)
    v_mfma_f32_32x32x16_bf16 v[48:63], v[84:87], v[164:167], v[48:63]
    v_exp_f32 v182, v182
    v_exp_f32 v183, v183
    v_cvt_pk_bf16_f32 v178, v180, v181
    v_exp_f32 v184, v184
    v_exp_f32 v185, v185
    v_cvt_pk_bf16_f32 v179, v182, v183
    v_exp_f32 v186, v186
    v_exp_f32 v187, v187
    ds_read_b128 v[80:83], v10 offset:12288
    v_cvt_pk_bf16_f32 v180, v184, v185
    v_exp_f32 v188, v188
    v_exp_f32 v189, v189
    ds_read_b128 v[84:87], v10 offset:13312
    v_cvt_pk_bf16_f32 v181, v186, v187
    v_exp_f32 v190, v190
    v_exp_f32 v191, v191
    v_cvt_pk_bf16_f32 v182, v188, v189
    v_cvt_pk_bf16_f32 v183, v190, v191
    v_exp_f32 v192, v192
    s_waitcnt lgkmcnt(7)
    v_mfma_f32_32x32x16_bf16 v[48:63], v[88:91], v[176:179], v[48:63]
    v_exp_f32 v193, v193
    v_exp_f32 v194, v194
    v_exp_f32 v195, v195
    v_cvt_pk_bf16_f32 v192, v192, v193
    v_exp_f32 v196, v196
    v_exp_f32 v197, v197
    v_cvt_pk_bf16_f32 v193, v194, v195
    s_waitcnt lgkmcnt(6)
    v_mfma_f32_32x32x16_bf16 v[48:63], v[92:95], v[180:183], v[48:63]
    v_exp_f32 v198, v198
    v_exp_f32 v199, v199
    v_cvt_pk_bf16_f32 v194, v196, v197
    v_exp_f32 v200, v200
    v_exp_f32 v201, v201
    v_cvt_pk_bf16_f32 v195, v198, v199
    v_exp_f32 v202, v202
    v_exp_f32 v203, v203
    ds_read_b128 v[88:91], v10 offset:14336
    v_cvt_pk_bf16_f32 v196, v200, v201
    v_exp_f32 v204, v204
    v_exp_f32 v205, v205
    ds_read_b128 v[92:95], v10 offset:15360
    v_cvt_pk_bf16_f32 v197, v202, v203
    v_exp_f32 v206, v206
    v_exp_f32 v207, v207
    v_cvt_pk_bf16_f32 v198, v204, v205
    v_cvt_pk_bf16_f32 v199, v206, v207
    v_exp_f32 v208, v208
    s_waitcnt lgkmcnt(7)
    v_mfma_f32_32x32x16_bf16 v[48:63], v[64:67], v[192:195], v[48:63]
    v_exp_f32 v209, v209
    v_exp_f32 v210, v210
    v_exp_f32 v211, v211
    v_cvt_pk_bf16_f32 v208, v208, v209
    v_exp_f32 v212, v212
    v_exp_f32 v213, v213
    v_cvt_pk_bf16_f32 v209, v210, v211
    s_waitcnt lgkmcnt(6)
    v_mfma_f32_32x32x16_bf16 v[48:63], v[68:71], v[196:199], v[48:63]
    v_exp_f32 v214, v214
    v_exp_f32 v215, v215
    v_cvt_pk_bf16_f32 v210, v212, v213
    v_exp_f32 v216, v216
    v_exp_f32 v217, v217
    v_cvt_pk_bf16_f32 v211, v214, v215
    v_exp_f32 v218, v218
    v_exp_f32 v219, v219
    ds_read_b128 v[64:67], v10 offset:16384
    v_cvt_pk_bf16_f32 v212, v216, v217
    v_exp_f32 v220, v220
    v_exp_f32 v221, v221
    ds_read_b128 v[68:71], v10 offset:17408
    v_cvt_pk_bf16_f32 v213, v218, v219
    v_exp_f32 v222, v222
    v_exp_f32 v223, v223
    v_cvt_pk_bf16_f32 v214, v220, v221
    v_cvt_pk_bf16_f32 v215, v222, v223
    s_waitcnt lgkmcnt(0)
    s_load_dwordx4 s[28:31], s[56:57], s64 glc
    s_load_dwordx4 s[32:35], s[56:57], s70 glc
    v_exp_f32 v224, v224
    v_mfma_f32_32x32x16_bf16 v[48:63], v[72:75], v[208:211], v[48:63]
    v_exp_f32 v225, v225
    v_exp_f32 v226, v226
    v_exp_f32 v227, v227
    v_cvt_pk_bf16_f32 v224, v224, v225
    v_exp_f32 v228, v228
    v_exp_f32 v229, v229
    v_cvt_pk_bf16_f32 v225, v226, v227
    v_exp_f32 v230, v230
    v_exp_f32 v231, v231
    v_cvt_pk_bf16_f32 v226, v228, v229
    v_exp_f32 v232, v232
    v_mfma_f32_32x32x16_bf16 v[48:63], v[76:79], v[212:215], v[48:63]
    v_exp_f32 v233, v233
    v_cvt_pk_bf16_f32 v227, v230, v231
    v_exp_f32 v234, v234
    v_exp_f32 v235, v235
    v_cvt_pk_bf16_f32 v228, v232, v233
    v_exp_f32 v236, v236
    v_exp_f32 v237, v237
    v_cvt_pk_bf16_f32 v229, v234, v235
    v_exp_f32 v238, v238
    v_exp_f32 v239, v239
    v_cvt_pk_bf16_f32 v230, v236, v237
    v_cvt_pk_bf16_f32 v231, v238, v239
    s_waitcnt vmcnt(0)
    v_mov_b32 v36, 65968
    v_mov_b32 v37, 1
    s_mov_b64 exec, 1
    ds_add_u32 v36, v37
    s_mov_b64 exec, -1
    v_exp_f32 v240, v240
    v_mfma_f32_32x32x16_bf16 v[48:63], v[80:83], v[224:227], v[48:63]
    v_exp_f32 v241, v241
    v_exp_f32 v242, v242
    v_exp_f32 v243, v243
    v_cvt_pk_bf16_f32 v240, v240, v241
    v_exp_f32 v244, v244
    v_exp_f32 v245, v245
    v_cvt_pk_bf16_f32 v241, v242, v243
    v_exp_f32 v246, v246
    v_exp_f32 v247, v247
    v_cvt_pk_bf16_f32 v242, v244, v245
    v_exp_f32 v248, v248
    v_mfma_f32_32x32x16_bf16 v[48:63], v[84:87], v[228:231], v[48:63]
    v_exp_f32 v249, v249
    v_cvt_pk_bf16_f32 v243, v246, v247
    v_exp_f32 v250, v250
    v_exp_f32 v251, v251
    v_cvt_pk_bf16_f32 v244, v248, v249
    v_exp_f32 v252, v252
    v_exp_f32 v253, v253
    v_cvt_pk_bf16_f32 v245, v250, v251
    v_exp_f32 v254, v254
    v_exp_f32 v255, v255
    v_cvt_pk_bf16_f32 v246, v252, v253
    v_cvt_pk_bf16_f32 v247, v254, v255
    v_exp_f32 v128, v128
    v_mfma_f32_32x32x16_bf16 v[48:63], v[88:91], v[240:243], v[48:63]
    v_exp_f32 v129, v129
    v_exp_f32 v130, v130
    v_exp_f32 v131, v131
    v_cvt_pk_bf16_f32 v128, v128, v129
    v_exp_f32 v132, v132
    v_exp_f32 v133, v133
    v_cvt_pk_bf16_f32 v129, v130, v131
    v_exp_f32 v134, v134
    v_exp_f32 v135, v135
    v_cvt_pk_bf16_f32 v130, v132, v133
    v_exp_f32 v136, v136
    v_mfma_f32_32x32x16_bf16 v[48:63], v[92:95], v[244:247], v[48:63]
    v_exp_f32 v137, v137
    v_cvt_pk_bf16_f32 v131, v134, v135
    v_exp_f32 v138, v138
    v_exp_f32 v139, v139
    v_cvt_pk_bf16_f32 v132, v136, v137
    v_exp_f32 v140, v140
    v_exp_f32 v141, v141
    v_cvt_pk_bf16_f32 v133, v138, v139
    v_exp_f32 v142, v142
    v_exp_f32 v143, v143
    v_cvt_pk_bf16_f32 v134, v140, v141
    v_cvt_pk_bf16_f32 v135, v142, v143
    v_mfma_f32_32x32x16_bf16 v[48:63], v[64:67], v[128:131], v[48:63]
    s_nop 0
    v_mfma_f32_32x32x16_bf16 v[48:63], v[68:71], v[132:135], v[48:63]
    s_nop 11
    v_subrev_u32 v12, 0x2b800000, v55
    v_cmp_le_u32 vcc, 0x28000000, v12
    s_cbranch_vccnz L_attx
L_attr1:
    v_rcp_f32 v12, v55
    s_nop 0
    v_mul_f32 v12, v12, v4
    v_mul_f32 v48, v48, v12
    v_mul_f32 v49, v49, v12
    v_cvt_pk_bf16_f32 v24, v48, v49
    v_mul_f32 v50, v50, v12
    v_mul_f32 v51, v51, v12
    v_cvt_pk_bf16_f32 v25, v50, v51
    v_mul_f32 v52, v52, v12
    v_mul_f32 v53, v53, v12
    v_cvt_pk_bf16_f32 v26, v52, v53
    v_mul_f32 v54, v54, v12
    v_cvt_pk_bf16_f32 v27, v54, 0
    v_or_b32 v27, s58, v27
    buffer_store_dwordx4 v[24:27], v5, s[36:39], 0 offen offset:0 sc1
    v_mul_f32 v56, v56, v12
    v_mul_f32 v57, v57, v12
    v_cvt_pk_bf16_f32 v28, v56, v57
    v_mul_f32 v58, v58, v12
    v_mul_f32 v59, v59, v12
    v_cvt_pk_bf16_f32 v29, v58, v59
    v_mul_f32 v60, v60, v12
    v_mul_f32 v61, v61, v12
    v_cvt_pk_bf16_f32 v30, v60, v61
    v_mul_f32 v62, v62, v12
    v_cvt_pk_bf16_f32 v31, v62, 0
    v_or_b32 v31, s58, v31
    buffer_store_dwordx4 v[28:31], v5, s[36:39], 0 offen offset:1024 sc1
    v_mov_b32 v20, s1
    v_mov_b32 v21, s26
    s_mov_b64 exec, 1
    buffer_store_dword v21, v20, s[36:39], 0 offen sc1
    s_mov_b64 exec, -1
    s_waitcnt lgkmcnt(0)
    s_setprio 0
    s_mov_b32 s74, 2
    s_mov_b32 s93, 0
    s_branch L_p3_chk
L_spin_P1:
    s_mov_b32 s93, 0
L_spin_P1_l:
    s_load_dwordx4 s[28:31], s[100:101], 0 glc
    s_load_dwordx4 s[32:35], s[100:101], 128 glc
    s_load_dwordx4 s[52:55], s[100:101], 256 glc
    s_load_dwordx4 s[80:83], s[100:101], 384 glc
    s_add_u32 s93, s93, 1
    s_cmp_gt_u32 s93, 100000
    s_waitcnt lgkmcnt(0)
    s_cbranch_scc1 L_go_P1
    s_xor_b64 s[28:29], s[28:29], s[26:27]
    s_xor_b64 s[30:31], s[30:31], s[26:27]
    s_or_b64 s[28:29], s[28:29], s[30:31]
    s_xor_b64 s[32:33], s[32:33], s[26:27]
    s_or_b64 s[28:29], s[28:29], s[32:33]
    s_xor_b64 s[34:35], s[34:35], s[26:27]
    s_or_b64 s[28:29], s[28:29], s[34:35]
    s_xor_b64 s[52:53], s[52:53], s[26:27]
    s_or_b64 s[28:29], s[28:29], s[52:53]
    s_xor_b64 s[54:55], s[54:55], s[26:27]
    s_or_b64 s[28:29], s[28:29], s[54:55]
    s_xor_b64 s[80:81], s[80:81], s[26:27]
    s_or_b64 s[28:29], s[28:29], s[80:81]
    s_xor_b64 s[82:83], s[82:83], s[26:27]
    s_or_b64 s[28:29], s[28:29], s[82:83]
    s_cbranch_scc1 L_spin_P1_l
    s_branch L_go_P1
L_spin_F:
    s_mov_b32 s93, 0
L_spin_F_l:
    s_load_dword s28, s[100:101], 0 glc
    s_load_dword s29, s[100:101], 128 glc
    s_load_dword s30, s[100:101], 256 glc
    s_load_dword s31, s[100:101], 384 glc
    s_load_dword s32, s[100:101], 512 glc
    s_load_dword s33, s[100:101], 640 glc
    s_load_dword s34, s[100:101], 768 glc
    s_load_dword s35, s[100:101], 896 glc
    s_add_u32 s93, s93, 1
    s_cmp_gt_u32 s93, 100000
    s_waitcnt lgkmcnt(0)
    s_cbranch_scc1 L_go_F
    s_xor_b64 s[28:29], s[28:29], s[26:27]
    s_xor_b64 s[30:31], s[30:31], s[26:27]
    s_or_b64 s[28:29], s[28:29], s[30:31]
    s_xor_b64 s[32:33], s[32:33], s[26:27]
    s_or_b64 s[28:29], s[28:29], s[32:33]
    s_xor_b64 s[34:35], s[34:35], s[26:27]
    s_or_b64 s[28:29], s[28:29], s[34:35]
    s_cbranch_scc1 L_spin_F_l
    s_branch L_go_F
L_red:
    s_setprio 2
    s_load_dwordx4 s[28:31], s[100:101], 0 glc
    s_load_dwordx4 s[32:35], s[100:101], 128 glc
    s_load_dwordx4 s[52:55], s[100:101], 256 glc
    s_load_dwordx4 s[80:83], s[100:101], 384 glc
    v_and_b32 v12, 31, v0
    v_bfe_u32 v13, v0, 5, 1
    v_lshlrev_b32 v13, 2, v13
    v_sub_u32 v12, v12, v13
    v_mov_b32 v13, 0x3f80
    v_mov_b32 v14, 0x3f800000
    v_cmp_eq_u32 vcc, 0, v12
    v_cmp_eq_u32 s[94:95], 1, v12
    s_nop 0
    v_cndmask_b32_e64 v32, 0, v13, vcc
    v_cndmask_b32_e64 v32, v32, v14, s[94:95]
    v_cmp_eq_u32 vcc, 2, v12
    v_cmp_eq_u32 s[94:95], 3, v12
    s_nop 0
    v_cndmask_b32_e64 v33, 0, v13, vcc
    v_cndmask_b32_e64 v33, v33, v14, s[94:95]
    v_cmp_eq_u32 vcc, 8, v12
    v_cmp_eq_u32 s[94:95], 9, v12
    s_nop 0
    v_cndmask_b32_e64 v34, 0, v13, vcc
    v_cndmask_b32_e64 v34, v34, v14, s[94:95]
    v_cmp_eq_u32 vcc, 10, v12
    v_cmp_eq_u32 s[94:95], 11, v12
    s_nop 0
    v_cndmask_b32_e64 v35, 0, v13, vcc
    v_cndmask_b32_e64 v35, v35, v14, s[94:95]
    v_cvt_pk_bf16_f32 v36, v96, v97
    v_cvt_pk_bf16_f32 v37, v98, v99
    v_cvt_pk_bf16_f32 v38, v100, v101
    v_cvt_pk_bf16_f32 v39, v102, v103
    v_cvt_pk_bf16_f32 v40, v104, v105
    v_cvt_pk_bf16_f32 v41, v106, v107
    v_cvt_pk_bf16_f32 v42, v108, v109
    v_cvt_pk_bf16_f32 v43, v110, v111
    v_permlane16_swap_b32 v36, v38
    v_permlane16_swap_b32 v37, v39
    v_permlane16_swap_b32 v40, v42
    v_permlane16_swap_b32 v41, v43
    v_cndmask_b32 v42, v42, 0, s[90:91]
    v_mfma_f32_32x32x16_bf16 v[112:127], v[24:27], v[36:39], 0
    s_nop 0
    v_mfma_f32_32x32x16_bf16 v[112:127], v[28:31], v[40:43], v[112:127]
    v_mul_f32 v4, 0xbfb8aa3b, v108
    v_mul_f32 v12, 0xbfb8aa3b, v104
    s_nop 1
    v_permlane16_swap_b32 v12, v4
    v_mov_b32 v12, v4
    s_nop 1
    v_permlane32_swap_b32 v12, v4
    v_exp_f32 v4, v4
    s_nop 0
    v_add_f32 v4, 1.0, v4
    v_rcp_f32 v4, v4
    s_waitcnt lgkmcnt(0)
    s_xor_b64 s[28:29], s[28:29], s[26:27]
    s_xor_b64 s[30:31], s[30:31], s[26:27]
    s_or_b64 s[28:29], s[28:29], s[30:31]
    s_xor_b64 s[32:33], s[32:33], s[26:27]
    s_or_b64 s[28:29], s[28:29], s[32:33]
    s_xor_b64 s[34:35], s[34:35], s[26:27]
    s_or_b64 s[28:29], s[28:29], s[34:35]
    s_xor_b64 s[52:53], s[52:53], s[26:27]
    s_or_b64 s[28:29], s[28:29], s[52:53]
    s_xor_b64 s[54:55], s[54:55], s[26:27]
    s_or_b64 s[28:29], s[28:29], s[54:55]
    s_xor_b64 s[80:81], s[80:81], s[26:27]
    s_or_b64 s[28:29], s[28:29], s[80:81]
    s_xor_b64 s[82:83], s[82:83], s[26:27]
    s_or_b64 s[28:29], s[28:29], s[82:83]
    s_cbranch_scc1 L_spin_P1
L_go_P1:
    s_add_u32 s99, s16, 0
    buffer_load_dwordx4 v[144:147], v1, s[36:39], s99 offen offset:0 sc1
    buffer_load_dwordx4 v[148:151], v1, s[36:39], s99 offen offset:2048 sc1
    s_add_u32 s99, s16, 4096
    buffer_load_dwordx4 v[152:155], v1, s[36:39], s99 offen offset:0 sc1
    buffer_load_dwordx4 v[156:159], v1, s[36:39], s99 offen offset:2048 sc1
    s_add_u32 s99, s16, 8192
    buffer_load_dwordx4 v[160:163], v1, s[36:39], s99 offen offset:0 sc1
    buffer_load_dwordx4 v[164:167], v1, s[36:39], s99 offen offset:2048 sc1
    s_add_u32 s99, s16, 12288
    buffer_load_dwordx4 v[168:171], v1, s[36:39], s99 offen offset:0 sc1
    buffer_load_dwordx4 v[172:175], v1, s[36:39], s99 offen offset:2048 sc1
    s_add_u32 s99, s16, 16384
    buffer_load_dwordx4 v[176:179], v1, s[36:39], s99 offen offset:0 sc1
    buffer_load_dwordx4 v[180:183], v1, s[36:39], s99 offen offset:2048 sc1
    s_add_u32 s99, s16, 20480
    buffer_load_dwordx4 v[184:187], v1, s[36:39], s99 offen offset:0 sc1
    buffer_load_dwordx4 v[188:191], v1, s[36:39], s99 offen offset:2048 sc1
    s_add_u32 s99, s16, 24576
    buffer_load_dwordx4 v[192:195], v1, s[36:39], s99 offen offset:0 sc1
    buffer_load_dwordx4 v[196:199], v1, s[36:39], s99 offen offset:2048 sc1
    s_add_u32 s99, s16, 28672
    buffer_load_dwordx4 v[200:203], v1, s[36:39], s99 offen offset:0 sc1
    buffer_load_dwordx4 v[204:207], v1, s[36:39], s99 offen offset:2048 sc1
    v_exp_f32_e64 v128, -v112
    v_exp_f32 v112, v112
    v_exp_f32_e64 v129, -v113
    v_exp_f32 v113, v113
    v_exp_f32_e64 v130, -v114
    v_exp_f32 v114, v114
    v_exp_f32_e64 v131, -v115
    v_exp_f32 v115, v115
    v_exp_f32_e64 v132, -v116
    v_exp_f32 v116, v116
    v_exp_f32_e64 v133, -v117
    v_exp_f32 v117, v117
    v_exp_f32_e64 v134, -v118
    v_exp_f32 v118, v118
    v_exp_f32_e64 v135, -v126
    v_exp_f32 v119, v126
    v_exp_f32_e64 v136, -v120
    v_exp_f32 v120, v120
    v_exp_f32_e64 v137, -v121
    v_exp_f32 v121, v121
    v_exp_f32_e64 v138, -v122
    v_exp_f32 v122, v122
    v_exp_f32_e64 v139, -v123
L_sum:
    s_waitcnt vmcnt(15)
    v_xor_b32 v147, s58, v147
    v_mov_b32 v22, v147
    s_nop 0
    v_mfma_f32_32x32x16_bf16 v[48:63], v[32:35], v[144:147], 0
    s_waitcnt vmcnt(14)
    v_xor_b32 v151, s58, v151
    v_or_b32 v22, v22, v151
    s_nop 0
    v_mfma_f32_32x32x16_bf16 v[48:63], v[32:35], v[148:151], v[48:63]
    s_waitcnt vmcnt(13)
    v_xor_b32 v155, s58, v155
    v_or_b32 v22, v22, v155
    s_nop 0
    v_mfma_f32_32x32x16_bf16 v[48:63], v[32:35], v[152:155], v[48:63]
    s_waitcnt vmcnt(12)
    v_xor_b32 v159, s58, v159
    v_or_b32 v22, v22, v159
    s_nop 0
    v_mfma_f32_32x32x16_bf16 v[48:63], v[32:35], v[156:159], v[48:63]
    s_waitcnt vmcnt(11)
    v_xor_b32 v163, s58, v163
    v_or_b32 v22, v22, v163
    s_nop 0
    v_mfma_f32_32x32x16_bf16 v[48:63], v[32:35], v[160:163], v[48:63]
    s_waitcnt vmcnt(10)
    v_xor_b32 v167, s58, v167
    v_or_b32 v22, v22, v167
    s_nop 0
    v_mfma_f32_32x32x16_bf16 v[48:63], v[32:35], v[164:167], v[48:63]
    s_waitcnt vmcnt(9)
    v_xor_b32 v171, s58, v171
    v_or_b32 v22, v22, v171
    s_nop 0
    v_mfma_f32_32x32x16_bf16 v[48:63], v[32:35], v[168:171], v[48:63]
    s_waitcnt vmcnt(8)
    v_xor_b32 v175, s58, v175
    v_or_b32 v22, v22, v175
    s_nop 0
    v_mfma_f32_32x32x16_bf16 v[48:63], v[32:35], v[172:175], v[48:63]
    s_waitcnt vmcnt(7)
    v_xor_b32 v179, s58, v179
    v_or_b32 v22, v22, v179
    s_nop 0
    v_mfma_f32_32x32x16_bf16 v[48:63], v[32:35], v[176:179], v[48:63]
    s_waitcnt vmcnt(6)
    v_xor_b32 v183, s58, v183
    v_or_b32 v22, v22, v183
    s_nop 0
    v_mfma_f32_32x32x16_bf16 v[48:63], v[32:35], v[180:183], v[48:63]
    s_waitcnt vmcnt(5)
    v_xor_b32 v187, s58, v187
    v_or_b32 v22, v22, v187
    s_nop 0
    v_mfma_f32_32x32x16_bf16 v[48:63], v[32:35], v[184:187], v[48:63]
    s_waitcnt vmcnt(4)
    v_xor_b32 v191, s58, v191
    v_or_b32 v22, v22, v191
    s_nop 0
    v_mfma_f32_32x32x16_bf16 v[48:63], v[32:35], v[188:191], v[48:63]
    s_waitcnt vmcnt(3)
    v_xor_b32 v195, s58, v195
    v_or_b32 v22, v22, v195
    s_nop 0
    v_mfma_f32_32x32x16_bf16 v[48:63], v[32:35], v[192:195], v[48:63]
    s_waitcnt vmcnt(2)
    v_xor_b32 v199, s58, v199
    v_or_b32 v22, v22, v199
    s_nop 0
    v_mfma_f32_32x32x16_bf16 v[48:63], v[32:35], v[196:199], v[48:63]
    s_waitcnt vmcnt(1)
    v_xor_b32 v203, s58, v203
    v_or_b32 v22, v22, v203
    s_nop 0
    v_mfma_f32_32x32x16_bf16 v[48:63], v[32:35], v[200:203], v[48:63]
    s_waitcnt vmcnt(0)
    v_xor_b32 v207, s58, v207
    v_or_b32 v22, v22, v207
    s_nop 0
    v_mfma_f32_32x32x16_bf16 v[48:63], v[32:35], v[204:207], v[48:63]
    v_cmp_lt_u32 vcc, 0xffff, v22
    s_add_u32 s59, s59, 1
    s_cmp_gt_u32 s59, 100000
    s_cbranch_scc1 L_rp_ok
    s_cbranch_vccnz L_rp
L_rp_ok:
    s_add_u32 s100, s36, s92
    s_addc_u32 s101, s37, 0
    s_atomic_add s26, s[36:37], s0
    s_nop 3
    s_nop 0
    v_cvt_pk_bf16_f32 v80, v48, v49
    v_cvt_pk_bf16_f32 v81, v50, v51
    v_cvt_pk_bf16_f32 v82, v52, v53
    v_cvt_pk_bf16_f32 v83, v54, 0
    v_or_b32 v83, s58, v83
    buffer_store_dwordx4 v[80:83], v1, s[36:39], s17 offen sc1
    v_exp_f32 v123, v123
    v_exp_f32_e64 v140, -v124
    v_exp_f32 v124, v124
    v_exp_f32_e64 v141, -v125
    v_exp_f32 v125, v125
    v_pk_add_f32 v[18:19], v[112:113], v[114:115]
    v_pk_add_f32 v[20:21], v[128:129], v[130:131]
    v_pk_add_f32 v[18:19], v[18:19], v[116:117]
    v_pk_add_f32 v[20:21], v[20:21], v[132:133]
    v_pk_add_f32 v[18:19], v[18:19], v[118:119]
    v_pk_add_f32 v[20:21], v[20:21], v[134:135]
    v_pk_add_f32 v[18:19], v[18:19], v[120:121]
    v_pk_add_f32 v[20:21], v[20:21], v[136:137]
    v_pk_add_f32 v[18:19], v[18:19], v[122:123]
    v_pk_add_f32 v[20:21], v[20:21], v[138:139]
    v_pk_add_f32 v[18:19], v[18:19], v[124:125]
    v_pk_add_f32 v[20:21], v[20:21], v[140:141]
    v_add_f32 v12, v18, v19
    v_add_f32 v13, v20, v21
    s_nop 1
    v_permlane32_swap_b32 v12, v13
    v_add_f32 v12, v12, v13
    v_subrev_u32 v13, 0xf800000, v12
    v_cmp_le_u32 vcc, 0x6c000000, v13
    s_mov_b32 s98, 4
    s_cbranch_vccnz L_phixq
L_phir_qr:
    v_rcp_f32 v14, v12
    s_load_dword s28, s[100:101], 0 glc
    s_load_dword s29, s[100:101], 128 glc
    s_load_dword s30, s[100:101], 256 glc
    s_load_dword s31, s[100:101], 384 glc
    s_load_dword s32, s[100:101], 512 glc
    s_load_dword s33, s[100:101], 640 glc
    s_load_dword s34, s[100:101], 768 glc
    s_load_dword s35, s[100:101], 896 glc
    v_mov_b32 v16, v14
    s_nop 1
    v_permlane32_swap_b32 v14, v16
    v_pk_mul_f32 v[112:113], v[112:113], v[14:15] op_sel_hi:[1,0]
    v_cvt_pk_bf16_f32 v64, v112, v113
    v_pk_mul_f32 v[128:129], v[128:129], v[16:17] op_sel_hi:[1,0]
    v_cvt_pk_bf16_f32 v72, v128, v129
    v_pk_mul_f32 v[114:115], v[114:115], v[14:15] op_sel_hi:[1,0]
    v_cvt_pk_bf16_f32 v65, v114, v115
    v_pk_mul_f32 v[130:131], v[130:131], v[16:17] op_sel_hi:[1,0]
    v_cvt_pk_bf16_f32 v73, v130, v131
    v_pk_mul_f32 v[116:117], v[116:117], v[14:15] op_sel_hi:[1,0]
    v_cvt_pk_bf16_f32 v66, v116, v117
    v_pk_mul_f32 v[132:133], v[132:133], v[16:17] op_sel_hi:[1,0]
    v_cvt_pk_bf16_f32 v74, v132, v133
    v_pk_mul_f32 v[118:119], v[118:119], v[14:15] op_sel_hi:[1,0]
    v_cvt_pk_bf16_f32 v67, v118, 0
    v_pk_mul_f32 v[134:135], v[134:135], v[16:17] op_sel_hi:[1,0]
    v_cvt_pk_bf16_f32 v75, v134, 0
    v_pk_mul_f32 v[120:121], v[120:121], v[14:15] op_sel_hi:[1,0]
    v_cvt_pk_bf16_f32 v68, v120, v121
    v_pk_mul_f32 v[136:137], v[136:137], v[16:17] op_sel_hi:[1,0]
    v_cvt_pk_bf16_f32 v76, v136, v137
    v_pk_mul_f32 v[122:123], v[122:123], v[14:15] op_sel_hi:[1,0]
    v_cvt_pk_bf16_f32 v69, v122, v123
    v_pk_mul_f32 v[138:139], v[138:139], v[16:17] op_sel_hi:[1,0]
    v_cvt_pk_bf16_f32 v77, v138, v139
    v_pk_mul_f32 v[124:125], v[124:125], v[14:15] op_sel_hi:[1,0]
    v_cvt_pk_bf16_f32 v70, v124, v125
    v_pk_mul_f32 v[140:141], v[140:141], v[16:17] op_sel_hi:[1,0]
    v_cvt_pk_bf16_f32 v78, v140, v141
    v_cvt_pk_bf16_f32 v71, v119, 0
    v_cvt_pk_bf16_f32 v79, v135, 0
    s_waitcnt lgkmcnt(0)
    s_xor_b64 s[28:29], s[28:29], s[26:27]
    s_xor_b64 s[30:31], s[30:31], s[26:27]
    s_or_b64 s[28:29], s[28:29], s[30:31]
    s_xor_b64 s[32:33], s[32:33], s[26:27]
    s_or_b64 s[28:29], s[28:29], s[32:33]
    s_xor_b64 s[34:35], s[34:35], s[26:27]
    s_or_b64 s[28:29], s[28:29], s[34:35]
    s_cbranch_scc1 L_spin_F
L_go_F:
    s_setprio 0
    s_branch L_redj
L_rp:
    s_nop 7
    s_nop 7
    s_add_u32 s99, s16, 0
    buffer_load_dwordx4 v[144:147], v1, s[36:39], s99 offen offset:0 sc1
    buffer_load_dwordx4 v[148:151], v1, s[36:39], s99 offen offset:2048 sc1
    s_add_u32 s99, s16, 4096
    buffer_load_dwordx4 v[152:155], v1, s[36:39], s99 offen offset:0 sc1
    buffer_load_dwordx4 v[156:159], v1, s[36:39], s99 offen offset:2048 sc1
    s_add_u32 s99, s16, 8192
    buffer_load_dwordx4 v[160:163], v1, s[36:39], s99 offen offset:0 sc1
    buffer_load_dwordx4 v[164:167], v1, s[36:39], s99 offen offset:2048 sc1
    s_add_u32 s99, s16, 12288
    buffer_load_dwordx4 v[168:171], v1, s[36:39], s99 offen offset:0 sc1
    buffer_load_dwordx4 v[172:175], v1, s[36:39], s99 offen offset:2048 sc1
    s_add_u32 s99, s16, 16384
    buffer_load_dwordx4 v[176:179], v1, s[36:39], s99 offen offset:0 sc1
    buffer_load_dwordx4 v[180:183], v1, s[36:39], s99 offen offset:2048 sc1
    s_add_u32 s99, s16, 20480
    buffer_load_dwordx4 v[184:187], v1, s[36:39], s99 offen offset:0 sc1
    buffer_load_dwordx4 v[188:191], v1, s[36:39], s99 offen offset:2048 sc1
    s_add_u32 s99, s16, 24576
    buffer_load_dwordx4 v[192:195], v1, s[36:39], s99 offen offset:0 sc1
    buffer_load_dwordx4 v[196:199], v1, s[36:39], s99 offen offset:2048 sc1
    s_add_u32 s99, s16, 28672
    buffer_load_dwordx4 v[200:203], v1, s[36:39], s99 offen offset:0 sc1
    buffer_load_dwordx4 v[204:207], v1, s[36:39], s99 offen offset:2048 sc1
    s_waitcnt vmcnt(0)
    s_branch L_sum
L_w3:
    s_waitcnt vmcnt(0) lgkmcnt(0)
    s_branch L_w3k
L_spin_K:
    s_mov_b32 s93, 0
L_spin_K_l:
    s_load_dword s52, s[100:101], s92 glc
    s_load_dword s53, s[100:101], s94 glc
    s_add_u32 s93, s93, 1
    s_cmp_gt_u32 s93, 100000
    s_waitcnt lgkmcnt(0)
    s_cbranch_scc1 L_go_K
    s_xor_b64 s[52:53], s[52:53], s[26:27]
    s_cbranch_scc1 L_spin_K_l
    s_branch L_go_K
L_oc0b_r:
    s_add_u32 s59, s59, 1
    s_cmp_gt_u32 s59, 100000
    s_cbranch_scc1 L_oc0b_ok
    s_add_u32 s89, s22, 0
    buffer_load_dwordx4 v[128:131], v53, s[36:39], s89 offen offset:0 sc1
    buffer_load_dwordx4 v[132:135], v53, s[36:39], s89 offen offset:256 sc1
    buffer_load_dwordx4 v[136:139], v53, s[36:39], s89 offen offset:2048 sc1
    buffer_load_dwordx4 v[140:143], v53, s[36:39], s89 offen offset:2304 sc1
    s_waitcnt vmcnt(0)
    s_branch L_oc0b
L_oc2b_r:
    s_add_u32 s59, s59, 1
    s_cmp_gt_u32 s59, 100000
    s_cbranch_scc1 L_oc2b_ok
    s_add_u32 s89, s22, 4096
    buffer_load_dwordx4 v[144:147], v53, s[36:39], s89 offen offset:0 sc1
    buffer_load_dwordx4 v[148:151], v53, s[36:39], s89 offen offset:256 sc1
    buffer_load_dwordx4 v[152:155], v53, s[36:39], s89 offen offset:2048 sc1
    buffer_load_dwordx4 v[156:159], v53, s[36:39], s89 offen offset:2304 sc1
    s_waitcnt vmcnt(0)
    s_branch L_oc2b
L_oc0_r:
    s_add_u32 s59, s59, 1
    s_cmp_gt_u32 s59, 100000
    s_cbranch_scc1 L_oc0_ok
    s_add_u32 s89, s22, 0
    buffer_load_dwordx4 v[128:131], v53, s[36:39], s89 offen offset:0 sc1
    buffer_load_dwordx4 v[132:135], v53, s[36:39], s89 offen offset:256 sc1
    buffer_load_dwordx4 v[136:139], v53, s[36:39], s89 offen offset:2048 sc1
    buffer_load_dwordx4 v[140:143], v53, s[36:39], s89 offen offset:2304 sc1
    s_waitcnt vmcnt(0)
    s_branch L_oc0
L_oc2_r:
    s_add_u32 s59, s59, 1
    s_cmp_gt_u32 s59, 100000
    s_cbranch_scc1 L_oc2_ok
    s_add_u32 s89, s22, 4096
    buffer_load_dwordx4 v[144:147], v53, s[36:39], s89 offen offset:0 sc1
    buffer_load_dwordx4 v[148:151], v53, s[36:39], s89 offen offset:256 sc1
    buffer_load_dwordx4 v[152:155], v53, s[36:39], s89 offen offset:2048 sc1
    buffer_load_dwordx4 v[156:159], v53, s[36:39], s89 offen offset:2304 sc1
    s_waitcnt vmcnt(0)
    s_branch L_oc2
L_oc0l_r:
    s_add_u32 s59, s59, 1
    s_cmp_gt_u32 s59, 100000
    s_cbranch_scc1 L_oc0l_ok
    s_add_u32 s89, s22, 0
    buffer_load_dwordx4 v[128:131], v53, s[36:39], s89 offen offset:0 sc1
    buffer_load_dwordx4 v[132:135], v53, s[36:39], s89 offen offset:256 sc1
    buffer_load_dwordx4 v[136:139], v53, s[36:39], s89 offen offset:2048 sc1
    buffer_load_dwordx4 v[140:143], v53, s[36:39], s89 offen offset:2304 sc1
    s_waitcnt vmcnt(0)
    s_branch L_oc0l
L_oc2l_r:
    s_add_u32 s59, s59, 1
    s_cmp_gt_u32 s59, 100000
    s_cbranch_scc1 L_oc2l_ok
    s_add_u32 s89, s22, 4096
    buffer_load_dwordx4 v[144:147], v53, s[36:39], s89 offen offset:0 sc1
    buffer_load_dwordx4 v[148:151], v53, s[36:39], s89 offen offset:256 sc1
    buffer_load_dwordx4 v[152:155], v53, s[36:39], s89 offen offset:2048 sc1
    buffer_load_dwordx4 v[156:159], v53, s[36:39], s89 offen offset:2304 sc1
    s_waitcnt vmcnt(0)
    s_branch L_oc2l
L_oc4_r:
    s_add_u32 s59, s59, 1
    s_cmp_gt_u32 s59, 100000
    s_cbranch_scc1 L_oc4_ok
    s_add_u32 s89, s23, 0
    buffer_load_dwordx4 v[160:163], v53, s[36:39], s89 offen offset:0 sc1
    buffer_load_dwordx4 v[164:167], v53, s[36:39], s89 offen offset:256 sc1
    buffer_load_dwordx4 v[168:171], v53, s[36:39], s89 offen offset:2048 sc1
    buffer_load_dwordx4 v[172:175], v53, s[36:39], s89 offen offset:2304 sc1
    s_waitcnt vmcnt(0)
    s_branch L_oc4
L_oc6_r:
    s_add_u32 s59, s59, 1
    s_cmp_gt_u32 s59, 100000
    s_cbranch_scc1 L_oc6_ok
    s_add_u32 s89, s23, 4096
    buffer_load_dwordx4 v[176:179], v53, s[36:39], s89 offen offset:0 sc1
    buffer_load_dwordx4 v[180:183], v53, s[36:39], s89 offen offset:256 sc1
    buffer_load_dwordx4 v[184:187], v53, s[36:39], s89 offen offset:2048 sc1
    buffer_load_dwordx4 v[188:191], v53, s[36:39], s89 offen offset:2304 sc1
    s_waitcnt vmcnt(0)
    s_branch L_oc6
L_phixk:
    s_waitcnt lgkmcnt(0)
    v_mfma_f32_32x32x16_bf16 v[112:127], v[24:27], v[64:67], 0
    v_mfma_f32_32x32x16_bf16 v[112:127], v[28:31], v[68:71], v[112:127]
    s_nop 11
    v_max_f32 v12, v118, v126
    v_max_f32_e64 v13, -v118, -v126
    v_max3_f32 v12, v12, v112, v113
    v_max3_f32 v13, v13, -v112, -v113
    v_max3_f32 v12, v12, v114, v115
    v_max3_f32 v13, v13, -v114, -v115
    v_max3_f32 v12, v12, v116, v117
    v_max3_f32 v13, v13, -v116, -v117
    v_max3_f32 v12, v12, v120, v121
    v_max3_f32 v13, v13, -v120, -v121
    v_max3_f32 v12, v12, v122, v123
    v_max3_f32 v13, v13, -v122, -v123
    v_max3_f32 v12, v12, v124, v125
    v_max3_f32 v13, v13, -v124, -v125
    s_nop 1
    v_permlane32_swap_b32 v12, v13
    v_max_f32 v14, v12, v13
    v_max_f32 v16, v12, v13
    v_mov_b32 v119, v126
    s_nop 0
    v_permlane32_swap_b32 v14, v16
    v_add_f32 v128, v112, v16
    v_sub_f32 v112, v112, v14
    v_exp_f32_e64 v128, -v128
    v_exp_f32 v112, v112
    v_add_f32 v129, v113, v16
    v_sub_f32 v113, v113, v14
    v_exp_f32_e64 v129, -v129
    v_exp_f32 v113, v113
    v_add_f32 v130, v114, v16
    v_sub_f32 v114, v114, v14
    v_exp_f32_e64 v130, -v130
    v_exp_f32 v114, v114
    v_add_f32 v131, v115, v16
    v_sub_f32 v115, v115, v14
    v_exp_f32_e64 v131, -v131
    v_exp_f32 v115, v115
    v_add_f32 v132, v116, v16
    v_sub_f32 v116, v116, v14
    v_exp_f32_e64 v132, -v132
    v_exp_f32 v116, v116
    v_add_f32 v133, v117, v16
    v_sub_f32 v117, v117, v14
    v_exp_f32_e64 v133, -v133
    v_exp_f32 v117, v117
    v_add_f32 v134, v118, v16
    v_sub_f32 v118, v118, v14
    v_exp_f32_e64 v134, -v134
    v_exp_f32 v118, v118
    v_add_f32 v135, v119, v16
    v_sub_f32 v119, v119, v14
    v_exp_f32_e64 v135, -v135
    v_exp_f32 v119, v119
    v_add_f32 v136, v120, v16
    v_sub_f32 v120, v120, v14
    v_exp_f32_e64 v136, -v136
    v_exp_f32 v120, v120
    v_add_f32 v137, v121, v16
    v_sub_f32 v121, v121, v14
    v_exp_f32_e64 v137, -v137
    v_exp_f32 v121, v121
    v_add_f32 v138, v122, v16
    v_sub_f32 v122, v122, v14
    v_exp_f32_e64 v138, -v138
    v_exp_f32 v122, v122
    v_add_f32 v139, v123, v16
    v_sub_f32 v123, v123, v14
    v_exp_f32_e64 v139, -v139
    v_exp_f32 v123, v123
    v_add_f32 v140, v124, v16
    v_sub_f32 v124, v124, v14
    v_exp_f32_e64 v140, -v140
    v_exp_f32 v124, v124
    v_add_f32 v141, v125, v16
    v_sub_f32 v125, v125, v14
    v_exp_f32_e64 v141, -v141
    v_exp_f32 v125, v125
    v_pk_add_f32 v[18:19], v[112:113], v[114:115]
    v_pk_add_f32 v[20:21], v[128:129], v[130:131]
    v_pk_add_f32 v[18:19], v[18:19], v[116:117]
    v_pk_add_f32 v[20:21], v[20:21], v[132:133]
    v_pk_add_f32 v[18:19], v[18:19], v[118:119]
    v_pk_add_f32 v[20:21], v[20:21], v[134:135]
    v_pk_add_f32 v[18:19], v[18:19], v[120:121]
    v_pk_add_f32 v[20:21], v[20:21], v[136:137]
    v_pk_add_f32 v[18:19], v[18:19], v[122:123]
    v_pk_add_f32 v[20:21], v[20:21], v[138:139]
    v_pk_add_f32 v[18:19], v[18:19], v[124:125]
    v_pk_add_f32 v[20:21], v[20:21], v[140:141]
    v_add_f32 v12, v18, v19
    v_add_f32 v13, v20, v21
    s_nop 1
    v_permlane32_swap_b32 v12, v13
    v_add_f32 v12, v12, v13
    s_cmp_eq_u32 s98, 0
    s_cbranch_scc1 L_phir_k0
    s_branch L_phir_k1
L_phixq:
    s_waitcnt lgkmcnt(0)
    v_mfma_f32_32x32x16_bf16 v[112:127], v[24:27], v[36:39], 0
    v_mfma_f32_32x32x16_bf16 v[112:127], v[28:31], v[40:43], v[112:127]
    s_nop 11
    v_max_f32 v12, v118, v126
    v_max_f32_e64 v13, -v118, -v126
    v_max3_f32 v12, v12, v112, v113
    v_max3_f32 v13, v13, -v112, -v113
    v_max3_f32 v12, v12, v114, v115
    v_max3_f32 v13, v13, -v114, -v115
    v_max3_f32 v12, v12, v116, v117
    v_max3_f32 v13, v13, -v116, -v117
    v_max3_f32 v12, v12, v120, v121
    v_max3_f32 v13, v13, -v120, -v121
    v_max3_f32 v12, v12, v122, v123
    v_max3_f32 v13, v13, -v122, -v123
    v_max3_f32 v12, v12, v124, v125
    v_max3_f32 v13, v13, -v124, -v125
    s_nop 1
    v_permlane32_swap_b32 v12, v13
    v_max_f32 v14, v12, v13
    v_max_f32 v16, v12, v13
    v_mov_b32 v119, v126
    s_nop 0
    v_permlane32_swap_b32 v14, v16
    v_add_f32 v128, v112, v16
    v_sub_f32 v112, v112, v14
    v_exp_f32_e64 v128, -v128
    v_exp_f32 v112, v112
    v_add_f32 v129, v113, v16
    v_sub_f32 v113, v113, v14
    v_exp_f32_e64 v129, -v129
    v_exp_f32 v113, v113
    v_add_f32 v130, v114, v16
    v_sub_f32 v114, v114, v14
    v_exp_f32_e64 v130, -v130
    v_exp_f32 v114, v114
    v_add_f32 v131, v115, v16
    v_sub_f32 v115, v115, v14
    v_exp_f32_e64 v131, -v131
    v_exp_f32 v115, v115
    v_add_f32 v132, v116, v16
    v_sub_f32 v116, v116, v14
    v_exp_f32_e64 v132, -v132
    v_exp_f32 v116, v116
    v_add_f32 v133, v117, v16
    v_sub_f32 v117, v117, v14
    v_exp_f32_e64 v133, -v133
    v_exp_f32 v117, v117
    v_add_f32 v134, v118, v16
    v_sub_f32 v118, v118, v14
    v_exp_f32_e64 v134, -v134
    v_exp_f32 v118, v118
    v_add_f32 v135, v119, v16
    v_sub_f32 v119, v119, v14
    v_exp_f32_e64 v135, -v135
    v_exp_f32 v119, v119
    v_add_f32 v136, v120, v16
    v_sub_f32 v120, v120, v14
    v_exp_f32_e64 v136, -v136
    v_exp_f32 v120, v120
    v_add_f32 v137, v121, v16
    v_sub_f32 v121, v121, v14
    v_exp_f32_e64 v137, -v137
    v_exp_f32 v121, v121
    v_add_f32 v138, v122, v16
    v_sub_f32 v122, v122, v14
    v_exp_f32_e64 v138, -v138
    v_exp_f32 v122, v122
    v_add_f32 v139, v123, v16
    v_sub_f32 v123, v123, v14
    v_exp_f32_e64 v139, -v139
    v_exp_f32 v123, v123
    v_add_f32 v140, v124, v16
    v_sub_f32 v124, v124, v14
    v_exp_f32_e64 v140, -v140
    v_exp_f32 v124, v124
    v_add_f32 v141, v125, v16
    v_sub_f32 v125, v125, v14
    v_exp_f32_e64 v141, -v141
    v_exp_f32 v125, v125
    v_pk_add_f32 v[18:19], v[112:113], v[114:115]
    v_pk_add_f32 v[20:21], v[128:129], v[130:131]
    v_pk_add_f32 v[18:19], v[18:19], v[116:117]
    v_pk_add_f32 v[20:21], v[20:21], v[132:133]
    v_pk_add_f32 v[18:19], v[18:19], v[118:119]
    v_pk_add_f32 v[20:21], v[20:21], v[134:135]
    v_pk_add_f32 v[18:19], v[18:19], v[120:121]
    v_pk_add_f32 v[20:21], v[20:21], v[136:137]
    v_pk_add_f32 v[18:19], v[18:19], v[122:123]
    v_pk_add_f32 v[20:21], v[20:21], v[138:139]
    v_pk_add_f32 v[18:19], v[18:19], v[124:125]
    v_pk_add_f32 v[20:21], v[20:21], v[140:141]
    v_add_f32 v12, v18, v19
    v_add_f32 v13, v20, v21
    s_nop 1
    v_permlane32_swap_b32 v12, v13
    v_add_f32 v12, v12, v13
    s_cmp_eq_u32 s98, 1
    s_cbranch_scc1 L_phir_q0
    s_cmp_eq_u32 s98, 3
    s_cbranch_scc1 L_phir_q1
    s_branch L_phir_qr
L_attx:
    s_waitcnt vmcnt(0) lgkmcnt(0)
    v_bfe_u32 v15, v0, 3, 1
    v_mul_u32_u24 v15, 120, v15
    v_bfe_u32 v13, v0, 4, 1
    v_lshl_add_u32 v15, v13, 7, v15
    v_sub_u32 v15, v1, v15
    v_bfe_u32 v13, v0, 5, 1
    v_lshl_add_u32 v16, v13, 30, v15
    v_lshlrev_b32 v13, 2, v13
    v_and_b32 v14, 31, v0
    v_and_b32 v17, 27, v14
    v_cmp_eq_u32 s[94:95], 11, v17
    v_sub_u32 v14, v14, v13
    v_mov_b32 v17, 0x3f803f80
    v_mov_b32 v12, 0xf149f2ca
    s_mov_b32 s53, 0
    s_mul_i32 s54, s69, 1792
    s_add_u32 s54, s54, 0x100000
    s_mul_i32 s55, s69, 448
    s_add_u32 s55, s55, 0x300000
    v_mov_b32 v48, 0
    v_mov_b32 v49, 0
    v_mov_b32 v50, 0
    v_mov_b32 v51, 0
    v_mov_b32 v52, 0
    v_mov_b32 v53, 0
    v_mov_b32 v54, 0
    v_mov_b32 v55, 0
    v_mov_b32 v56, 0
    v_mov_b32 v57, 0
    v_mov_b32 v58, 0
    v_mov_b32 v59, 0
    v_mov_b32 v60, 0
    v_mov_b32 v61, 0
    v_mov_b32 v62, 0
    v_mov_b32 v63, 0
L_attx_p:
    s_min_u32 s52, s14, 8
L_attx_t:
    s_sub_u32 s87, s14, s52
    s_mul_i32 s87, s87, 28672
    s_add_u32 s88, s87, s54
    s_add_u32 s87, s87, s55
    s_add_u32 s89, s87, 14336
    buffer_load_dwordx2 v[64:65], v15, s[36:39], s88 offen offset:0 sc1
    buffer_load_dwordx2 v[66:67], v15, s[36:39], s88 offen offset:256 sc1
    buffer_load_dwordx2 v[68:69], v15, s[36:39], s88 offen offset:1024 sc1
    buffer_load_dwordx2 v[70:71], v16, s[36:39], s88 offen offset:1280 sc1
    buffer_load_dwordx4 v[72:75], v9, s[36:39], s87 offen sc1
    buffer_load_dwordx4 v[76:79], v9, s[36:39], s89 offen sc1
    s_waitcnt vmcnt(0)
    v_mfma_f32_32x32x16_bf16 v[112:127], v[64:67], v[24:27], 0
    v_mfma_f32_32x32x16_bf16 v[112:127], v[68:71], v[28:31], v[112:127]
    v_cndmask_b32_e64 v72, v72, v17, s[94:95]
    v_cndmask_b32_e64 v73, v73, v17, s[94:95]
    v_cndmask_b32_e64 v74, v74, v17, s[94:95]
    v_cndmask_b32_e64 v75, v75, v17, s[94:95]
    v_cndmask_b32_e64 v76, v76, v17, s[94:95]
    v_cndmask_b32_e64 v77, v77, v17, s[94:95]
    v_cndmask_b32_e64 v78, v78, v17, s[94:95]
    v_cndmask_b32_e64 v79, v79, v17, s[94:95]
    s_lshl_b32 s87, s52, 5
    v_add_u32 v64, s87, v14
    v_mov_b32 v65, 0xf149f2ca
    v_subrev_u32 v13, 0, v64
    v_cmp_gt_u32 vcc, 0x100, v13
    s_nop 1
    v_cndmask_b32_e64 v112, v65, v112, vcc
    v_subrev_u32 v13, 1, v64
    v_cmp_gt_u32 vcc, 0x100, v13
    s_nop 1
    v_cndmask_b32_e64 v113, v65, v113, vcc
    v_subrev_u32 v13, 2, v64
    v_cmp_gt_u32 vcc, 0x100, v13
    s_nop 1
    v_cndmask_b32_e64 v114, v65, v114, vcc
    v_subrev_u32 v13, 3, v64
    v_cmp_gt_u32 vcc, 0x100, v13
    s_nop 1
    v_cndmask_b32_e64 v115, v65, v115, vcc
    v_subrev_u32 v13, 16, v64
    v_cmp_gt_u32 vcc, 0x100, v13
    s_nop 1
    v_cndmask_b32_e64 v116, v65, v116, vcc
    v_subrev_u32 v13, 17, v64
    v_cmp_gt_u32 vcc, 0x100, v13
    s_nop 1
    v_cndmask_b32_e64 v117, v65, v117, vcc
    v_subrev_u32 v13, 18, v64
    v_cmp_gt_u32 vcc, 0x100, v13
    s_nop 1
    v_cndmask_b32_e64 v118, v65, v118, vcc
    v_subrev_u32 v13, 19, v64
    v_cmp_gt_u32 vcc, 0x100, v13
    s_nop 1
    v_cndmask_b32_e64 v119, v65, v119, vcc
    v_subrev_u32 v13, 8, v64
    v_cmp_gt_u32 vcc, 0x100, v13
    s_nop 1
    v_cndmask_b32_e64 v120, v65, v120, vcc
    v_subrev_u32 v13, 9, v64
    v_cmp_gt_u32 vcc, 0x100, v13
    s_nop 1
    v_cndmask_b32_e64 v121, v65, v121, vcc
    v_subrev_u32 v13, 10, v64
    v_cmp_gt_u32 vcc, 0x100, v13
    s_nop 1
    v_cndmask_b32_e64 v122, v65, v122, vcc
    v_subrev_u32 v13, 11, v64
    v_cmp_gt_u32 vcc, 0x100, v13
    s_nop 1
    v_cndmask_b32_e64 v123, v65, v123, vcc
    v_subrev_u32 v13, 24, v64
    v_cmp_gt_u32 vcc, 0x100, v13
    s_nop 1
    v_cndmask_b32_e64 v124, v65, v124, vcc
    v_subrev_u32 v13, 25, v64
    v_cmp_gt_u32 vcc, 0x100, v13
    s_nop 1
    v_cndmask_b32_e64 v125, v65, v125, vcc
    v_subrev_u32 v13, 26, v64
    v_cmp_gt_u32 vcc, 0x100, v13
    s_nop 1
    v_cndmask_b32_e64 v126, v65, v126, vcc
    v_subrev_u32 v13, 27, v64
    v_cmp_gt_u32 vcc, 0x100, v13
    s_nop 1
    v_cndmask_b32_e64 v127, v65, v127, vcc
    s_cmp_eq_u32 s53, 1
    s_cbranch_scc1 L_attx_e
    v_max3_f32 v12, v12, v112, v113
    v_max3_f32 v12, v12, v114, v115
    v_max3_f32 v12, v12, v116, v117
    v_max3_f32 v12, v12, v118, v119
    v_max3_f32 v12, v12, v120, v121
    v_max3_f32 v12, v12, v122, v123
    v_max3_f32 v12, v12, v124, v125
    v_max3_f32 v12, v12, v126, v127
    s_branch L_attx_n
L_attx_e:
    v_sub_f32 v112, v112, v12
    v_exp_f32 v112, v112
    v_sub_f32 v113, v113, v12
    v_exp_f32 v113, v113
    v_sub_f32 v114, v114, v12
    v_exp_f32 v114, v114
    v_sub_f32 v115, v115, v12
    v_exp_f32 v115, v115
    v_sub_f32 v116, v116, v12
    v_exp_f32 v116, v116
    v_sub_f32 v117, v117, v12
    v_exp_f32 v117, v117
    v_sub_f32 v118, v118, v12
    v_exp_f32 v118, v118
    v_sub_f32 v119, v119, v12
    v_exp_f32 v119, v119
    v_sub_f32 v120, v120, v12
    v_exp_f32 v120, v120
    v_sub_f32 v121, v121, v12
    v_exp_f32 v121, v121
    v_sub_f32 v122, v122, v12
    v_exp_f32 v122, v122
    v_sub_f32 v123, v123, v12
    v_exp_f32 v123, v123
    v_sub_f32 v124, v124, v12
    v_exp_f32 v124, v124
    v_sub_f32 v125, v125, v12
    v_exp_f32 v125, v125
    v_sub_f32 v126, v126, v12
    v_exp_f32 v126, v126
    v_sub_f32 v127, v127, v12
    v_exp_f32 v127, v127
    v_cvt_pk_bf16_f32 v112, v112, v113
    v_cvt_pk_bf16_f32 v113, v114, v115
    v_cvt_pk_bf16_f32 v114, v116, v117
    v_cvt_pk_bf16_f32 v115, v118, v119
    v_cvt_pk_bf16_f32 v116, v120, v121
    v_cvt_pk_bf16_f32 v117, v122, v123
    v_cvt_pk_bf16_f32 v118, v124, v125
    v_cvt_pk_bf16_f32 v119, v126, v127
    v_mfma_f32_32x32x16_bf16 v[48:63], v[72:75], v[112:115], v[48:63]
    s_nop 0
    v_mfma_f32_32x32x16_bf16 v[48:63], v[76:79], v[116:119], v[48:63]
L_attx_n:
    s_sub_u32 s52, s52, 1
    s_cbranch_scc0 L_attx_t
    v_mov_b32 v13, v12
    s_add_u32 s53, s53, 1
    s_cmp_eq_u32 s53, 1
    v_permlane32_swap_b32 v12, v13
    v_max_f32 v12, v12, v13
    s_cbranch_scc1 L_attx_p
    s_nop 7
    s_cmp_eq_u32 s96, 0
    s_cbranch_scc1 L_attr0
    s_branch L_attr1
L_tailb:
    s_cmp_lg_u32 s2, 16
    s_cbranch_scc1 L_tail
    s_cmp_lg_u32 s66, 0
    s_cbranch_scc1 L_tail
    v_and_b32 v12, 15, v0
    v_bfe_u32 v13, v0, 4, 2
    v_lshrrev_b32 v14, 2, v12
    v_lshlrev_b32 v14, 7, v14
    v_and_b32 v15, 3, v12
    v_lshl_add_u32 v14, v15, 2, v14
    v_lshl_add_u32 v14, v13, 11, v14
    v_add_u32 v14, 65536, v14
    v_add_u32 v15, 0x2000, v14
    v_lshlrev_b32 v16, 10, v12
    v_lshl_add_u32 v16, v13, 7, v16
    v_add_u32 v16, 131072, v16
    s_mov_b32 s93, 0
L_tail_l:
    buffer_load_dword v24, v14, s[36:39], 0 offen sc1
    buffer_load_dword v25, v15, s[36:39], 0 offen sc1
    buffer_load_dword v26, v16, s[36:39], 0 offen sc1
    buffer_load_dword v27, v16, s[36:39], 0 offen offset:512 sc1
    s_add_u32 s93, s93, 1
    s_waitcnt vmcnt(0)
    v_xor_b32 v24, s26, v24
    v_xor_b32 v25, s26, v25
    v_xor_b32 v26, s26, v26
    v_xor_b32 v27, s26, v27
    v_or3_b32 v24, v24, v25, v26
    v_or_b32 v24, v24, v27
    v_cmp_ne_u32 vcc, 0, v24
    s_cmp_gt_u32 s93, 100000
    s_cbranch_scc1 L_tail_go
    s_cbranch_vccnz L_tail_l
L_tail_go:
    v_mov_b32 v20, 0
    v_mov_b32 v21, s26
    s_mov_b64 exec, 1
    buffer_store_dword v21, v20, s[36:39], 0 offen sc1
    s_mov_b64 exec, -1
L_tail:
L_end:
    s_endpgm
L_code_end:
.section .rodata,"a"
.p2align 6
.amdhsa_kernel gated_mix__linear_kernel_hedgehog__sliding_block__prompt_kernel
  .amdhsa_next_free_vgpr 256
  .amdhsa_next_free_sgpr 102
  .amdhsa_accum_offset 256
  .amdhsa_group_segment_fixed_size 0
  .amdhsa_kernarg_size 88
  .amdhsa_user_sgpr_count 2
  .amdhsa_user_sgpr_kernarg_segment_ptr 1
  .amdhsa_system_sgpr_workgroup_id_x 1
.end_amdhsa_kernel
```
